```python
import torch

def _softmax(x, axis=-1):
    return torch.softmax(x, dim=axis)
def _gelu(x):
    return torch.nn.functional.gelu(x, approximate="tanh")
def _silu(x):
    return torch.nn.functional.silu(x)
def _sigmoid(x):
    return torch.sigmoid(x)
def _layernorm(x, axis=-1, eps=1e-5):
    m = x.mean(dim=axis, keepdim=True)
    v = x.var(dim=axis, keepdim=True, unbiased=False)
    return (x - m) / torch.sqrt(v + eps)
def _scatter_add(tgt, idx, src, axis=0):
    return tgt.clone().index_add_(axis, idx, src)
def _segment_sum(src, seg, n):
    out = torch.zeros((n,) + src.shape[1:], dtype=src.dtype)
    return out.index_add_(0, seg, src)
def _pad(x, pw):
    flat = tuple(v for pair in reversed(pw) for v in pair)
    return torch.nn.functional.pad(x, flat)

kernel_name = 'parallel_sum__softmax_full_mha__dense_activation_squared_relu__prompt'

def setup_inputs():

    _w = (lambda a: (lambda t: t.to(torch.bfloat16) if t.is_floating_point() else t)(torch.as_tensor(a)))
    def _A_setup():
        B, S, D = 1, 2048, 512
        return {
            "x": _w((lambda *s: torch.randn(*s, dtype=torch.bfloat16) * 0.05)(B, S, D)),
            "wqkv": _w((lambda *s: torch.randn(*s, dtype=torch.bfloat16) * 0.2)(D, 3 * D)),
            "wo": _w((lambda *s: torch.randn(*s, dtype=torch.bfloat16) * 0.1)(D, D)),
        }
    _A_in = _A_setup()

    def _B_setup():
        B, S, D, F = 1, 2048, 512, 1376
        return {
            "x": _w((lambda *s: torch.randn(*s, dtype=torch.bfloat16) * 0.05)(B, S, D)),
            "w1": _w((lambda *s: torch.randn(*s, dtype=torch.bfloat16) * 0.1)(D, F)),
            "b1": _w((lambda *s: torch.randn(*s, dtype=torch.bfloat16) * 0.8)(F)),
            "w2": _w((lambda *s: torch.randn(*s, dtype=torch.bfloat16) * 0.1)(F, D)),
            "b2": _w((lambda *s: torch.randn(*s, dtype=torch.bfloat16) * 12.8)(D)),
        }
    _B_in = _B_setup()

    return {
        "A_x": _A_in["x"],
        "A_wqkv": _A_in["wqkv"],
        "A_wo": _A_in["wo"],
        "B_x": _B_in["x"],
        "B_w1": _B_in["w1"],
        "B_b1": _B_in["b1"],
        "B_w2": _B_in["w2"],
        "B_b2": _B_in["b2"],
    }

def reference(A_x, A_wqkv, A_wo, B_x, B_w1, B_b1, B_w2, B_b2):
    def _A_ref(x, wqkv, wo):
        B, S, D = x.shape
        H = 32; Dh = D // H
        qkv = (lambda x, *d: x.permute(*d))((x @ wqkv).reshape(B, S, 3, H, Dh), 2, 0, 3, 1, 4)
        q, k, v = qkv[0], qkv[1], qkv[2]
        scale = Dh ** -0.5
        scores = torch.einsum("bhqd,bhkd->bhqk", q, k) * scale
        p = _softmax(scores, axis=-1)
        o = torch.einsum("bhqk,bhkd->bhqd", p, v)
        return (lambda x, *d: x.permute(*d))(o, 0, 2, 1, 3).reshape(B, S, D) @ wo

    def _B_ref(x, w1, b1, w2, b2):
        h = torch.einsum("bsd,df->bsf", x, w1) + b1
        zero = torch.zeros_like(h)
        r = torch.where(h > zero, h, zero)
        h = r * r
        out = torch.einsum("bsf,fd->bsd", h, w2) + b2
        return out

    x = A_x
    xn = _layernorm(x, axis=-1)
    return x + _A_ref(xn, A_wqkv, A_wo) + _B_ref(xn, B_w1, B_b1, B_w2, B_b2)
```

```asm
; @launch grid=(256,1,1) block=(256,1,1) lds=163840
.amdgcn_target "amdgcn-amd-amdhsa--gfx950"
.text
.globl parallel_sum__softmax_full_mha__dense_activation_squared_relu__prompt_kernel
.p2align 8
.type parallel_sum__softmax_full_mha__dense_activation_squared_relu__prompt_kernel,@function
parallel_sum__softmax_full_mha__dense_activation_squared_relu__prompt_kernel:
    s_cmp_ge_u32 s2, 256
    s_cbranch_scc1 L_exit
    s_load_dwordx2 s[40:41], s[0:1], 0
    s_load_dwordx2 s[44:45], s[0:1], 8
    s_load_dwordx2 s[60:61], s[0:1], 80
    s_getpc_b64 s[84:85]
L_pc:
    s_mov_b64 s[34:35], s[84:85]
    v_lshrrev_b32 v1, 6, v0
    v_and_b32 v0, 63, v0
    v_readfirstlane_b32 s3, v1
    v_lshlrev_b32 v1, 4, v0
    s_and_b32 s12, s2, 7
    s_lshr_b32 s13, s2, 3
    s_lshl_b32 s12, s12, 2
    s_lshr_b32 s12, 0x73516240, s12
    s_and_b32 s12, s12, 7
    s_lshl_b32 s10, s3, 5
    s_add_u32 s10, s10, s13
    s_cmp_ge_u32 s10, (L_codeend-L_main)/1024+4
    s_cbranch_scc1 L_nopf
    s_add_u32 s86, s84, L_main-L_pc
    s_addc_u32 s87, s85, 0
    s_sub_u32 s86, s86, 4096
    s_subb_u32 s87, s87, 0
    s_lshl_b32 s10, s10, 10
    v_add_u32 v64, s10, v1
    global_load_dwordx4 v[64:67], v64, s[86:87]
L_nopf:
    s_and_b32 s10, s13, 7
    s_lshr_b32 s11, s13, 3
    s_and_b32 s5, s12, 1
    s_lshl_b32 s5, s5, 3
    s_add_u32 s5, s5, s10
    s_lshr_b32 s4, s12, 1
    s_lshl_b32 s4, s4, 2
    s_add_u32 s4, s4, s11
    s_lshl_b32 s6, s5, 2
    s_add_u32 s6, s6, s3
    s_lshl_b32 s84, s6, 15
    s_lshr_b32 s10, s4, 1
    s_xor_b32 s10, s10, 1
    s_lshl_b32 s10, s10, 7
    s_and_b32 s11, s4, 1
    s_add_u32 s11, s11, 1
    s_lshl_b32 s11, s11, 10
    s_add_u32 s10, s10, s11
    s_mul_i32 s86, s3, 49152
    s_add_u32 s85, s10, s86
    s_lshl_b32 s100, s3, 12
    s_lshl_b32 s101, s3, 11
    v_lshrrev_b32 v20, 3, v0
    v_and_b32 v21, 7, v0
    v_lshrrev_b32 v22, 4, v0
    v_xor_b32 v23, v21, v22
    v_lshlrev_b32 v23, 4, v23
    v_lshl_add_u32 v3, v20, 10, v23
    v_add_u32 v3, s84, v3
    v_xor_b32 v4, 64, v3
    v_add_u32 v4, 7168, v4
    v_add_u32 v5, 14336, v3
    v_add_u32 v6, 14336, v4
    v_and_b32 v22, 1, v22
    v_lshlrev_b32 v22, 2, v22
    v_xor_b32 v23, v21, v22
    v_lshlrev_b32 v23, 4, v23
    v_mul_u32_u24 v7, 3072, v20
    v_add3_u32 v7, v7, v23, s85
    v_add_u32 v8, 23552, v7
    s_mov_b32 s42, 2097152
    s_mov_b32 s43, 0x00020000
    s_mov_b32 s46, 1572864
    s_mov_b32 s47, 0x00020000
    s_mov_b32 s62, 8388608
    s_mov_b32 s63, 0x00020000
    s_and_b32 s10, s13, 7
    s_lshr_b32 s11, s13, 3
    s_add_u32 s10, s10, s11
    s_mul_i32 s11, s10, 11
    s_lshr_b32 s11, s11, 5
    s_mul_i32 s11, s11, 3
    s_sub_u32 s10, s10, s11
    s_lshl_b32 s10, s10, 3
    s_lshr_b32 s7, 0x375410, s10
    s_bfe_u32 s10, s7, 0x30000
    s_lshl_b32 s14, s10, 7
    s_mul_i32 s38, s10, 196608
    s_mul_i32 s28, s10, 176128
    s_bfe_u32 s10, s7, 0x30004
    s_lshl_b32 s15, s10, 7
    s_mul_i32 s39, s10, 196608
    s_mul_i32 s29, s10, 176128
    s_waitcnt lgkmcnt(0)
    s_add_u32 m0, s100, 0
    s_nop 0
    buffer_load_dwordx4 v3, s[40:43], s14 offen offset:0  lds
    buffer_load_dwordx4 v4, s[40:43], s14 offen offset:1024  lds
    buffer_load_dwordx4 v5, s[40:43], s14 offen offset:2048  lds
    buffer_load_dwordx4 v6, s[40:43], s14 offen offset:3072  lds
    s_add_u32 m0, s101, 49152
    s_nop 0
    buffer_load_dwordx4 v7, s[44:47], s38 offen offset:0  lds
    buffer_load_dwordx4 v8, s[44:47], s38 offen offset:1024  lds
    s_lshl_b32 s10, s3, 8
    s_add_u32 s10, s10, s2
    s_sub_u32 s97, s10, 176
    s_cmp_ge_u32 s97, 16
    s_cbranch_scc1 L_norst
    v_mov_b64 v[84:85], 0
    v_mov_b64 v[86:87], 0
    s_mul_i32 s10, s97, 2048
    s_add_u32 s10, s10, 6356992
    v_lshlrev_b32 v88, 3, v0
    s_mul_i32 s11, s97, 512
    s_add_u32 s11, s11, 6291456
    buffer_store_dwordx2 v[84:85], v88, s[60:63], s11 offen sc1
    buffer_store_dwordx4 v[84:87], v1, s[60:63], s10 offen offset:0 sc1
    buffer_store_dwordx4 v[84:87], v1, s[60:63], s10 offen offset:1024 sc1
    s_cmp_lg_u32 s97, 0
    s_cbranch_scc1 L_norst
    v_and_b32 v89, 7, v0
    v_and_b32 v85, 1, v0
    v_mul_u32_u24 v84, 0x3f80, v85
    v_lshl_or_b32 v84, v84, 16, v84
    v_bfe_u32 v86, v0, 3, 1
    v_lshlrev_b32 v86, 9, v86
    v_lshl_add_u32 v88, v89, 4, v86
    v_bfe_u32 v86, v0, 4, 2
    v_lshl_add_u32 v88, v86, 11, v88
    v_mov_b32 v85, v84
    v_mov_b64 v[86:87], v[84:85]
    s_mov_b32 s10, 6554624
    buffer_store_dwordx4 v[84:87], v88, s[60:63], s10 offen sc1
L_norst:
    s_lshr_b32 s10, s2, 1
    s_and_b32 s10, s10, 0x7c
    s_add_u32 s10, s10, L_perm-L_pc
    s_load_dword s7, s[34:35], s10
    s_add_u32 m0, s100, 16384
    s_nop 0
    buffer_load_dwordx4 v3, s[40:43], s15 offen offset:0  lds
    buffer_load_dwordx4 v4, s[40:43], s15 offen offset:1024  lds
    buffer_load_dwordx4 v5, s[40:43], s15 offen offset:2048  lds
    buffer_load_dwordx4 v6, s[40:43], s15 offen offset:3072  lds
    s_load_dwordx2 s[56:57], s[0:1], 16
    s_load_dwordx2 s[48:49], s[0:1], 32
    s_load_dwordx2 s[76:77], s[0:1], 40
    s_load_dwordx2 s[52:53], s[0:1], 48
    s_load_dwordx2 s[80:81], s[0:1], 56
    s_load_dwordx2 s[68:69], s[0:1], 64
    s_load_dwordx2 s[72:73], s[0:1], 72
    s_mov_b32 s58, 524288
    s_mov_b32 s59, 0x00020000
    s_mov_b32 s50, 1409024
    s_mov_b32 s51, 0x00020000
    s_mov_b32 s78, 2752
    s_mov_b32 s79, 0x00020000
    s_mov_b32 s54, 1409024
    s_mov_b32 s55, 0x00020000
    s_mov_b32 s82, 1024
    s_mov_b32 s83, 0x00020000
    s_mov_b32 s70, 2097152
    s_mov_b32 s71, 0x00020000
    s_mov_b32 s74, 256
    s_mov_b32 s75, 0x00020000
    s_mov_b32 s66, 5767168
    s_mov_b32 s67, 0x00020000
    s_and_b32 s8, s12, 1
    s_lshl_b32 s8, s8, 1
    s_bfe_u32 s10, s12, 0x10001
    s_add_u32 s8, s8, s10
    s_lshl_b32 s8, s8, 3
    s_and_b32 s10, s13, 7
    s_add_u32 s8, s8, s10
    s_and_b32 s9, s12, 4
    s_lshr_b32 s10, s13, 3
    s_add_u32 s9, s9, s10
    s_mov_b32 s88, 0x0000ffff
    s_mov_b32 s89, 0x0000ffff
    s_mov_b32 s90, 0
    s_mov_b32 s91, -1
    s_mov_b32 s92, 0x3f803f80
    s_mul_i32 s93, s4, 3
    s_bfm_b32 s10, s4, 0
    s_and_b32 s10, s10, 51968
    s_bcnt1_i32_b32 s10, s10
    s_sub_u32 s93, s93, s10
    s_mul_i32 s11, s3, 44032
    s_lshl_b32 s10, s93, 6
    s_add_u32 s11, s10, s11
    s_lshl_b32 s10, s4, 6
    s_add_u32 s10, s10, s86
    s_mul_i32 s96, s3, 40960
    v_lshrrev_b32 v20, 2, v0
    v_and_b32 v21, 3, v0
    v_lshlrev_b32 v22, 4, v21
    v_mul_u32_u24 v9, 3072, v20
    v_add3_u32 v9, v9, v22, s10
    v_mul_u32_u24 v10, 2752, v20
    v_add3_u32 v10, v10, v22, s11
    v_and_b32 v20, 31, v0
    v_lshrrev_b32 v22, 5, v0
    v_bfe_u32 v23, v0, 1, 3
    v_xor_b32 v23, v23, v22
    v_lshlrev_b32 v23, 4, v23
    v_lshl_add_u32 v11, v20, 7, v23
    s_mul_i32 s10, s3, 4128
    v_xor_b32 v11, s10, v11
    v_xor_b32 v12, 32, v11
    v_xor_b32 v13, 64, v11
    v_xor_b32 v14, 96, v11
    v_bfe_u32 v23, v0, 2, 2
    v_lshl_add_u32 v24, v22, 3, v23
    v_bfe_u32 v25, v0, 4, 1
    v_lshlrev_b32 v25, 5, v25
    v_lshl_add_u32 v25, v21, 3, v25
    v_lshl_add_u32 v63, v24, 6, v25
    v_add_u32 v63, s100, v63
    v_lshl_add_u32 v40, v24, 7, v25
    v_bfe_u32 v26, v0, 3, 1
    v_lshl_add_u32 v40, v26, 6, v40
    s_add_u32 s10, s101, 49152
    v_add_u32 v40, s10, v40
    v_xor_b32 v41, 64, v40
    v_xor_b32 v42, 2048, v40
    v_xor_b32 v43, 2112, v40
    v_xor_b32 v44, 4096, v40
    v_xor_b32 v45, 4160, v40
    v_xor_b32 v46, 6144, v40
    v_xor_b32 v47, 6208, v40
    v_bfe_u32 v23, v0, 1, 1
    v_xor_b32 v23, v23, v22
    v_bfe_u32 v24, v0, 2, 1
    v_lshl_or_b32 v23, v23, 1, v24
    v_mov_b32 v56, s92
    v_cmp_eq_u32 vcc, 0, v23
    v_mov_b32 v57, s92
    v_mov_b32 v15, 0
    v_cndmask_b32 v16, 0, v56, vcc
    v_cmp_eq_u32 vcc, 1, v23
    v_mov_b32 v17, v16
    v_and_b32 v24, 1, v0
    v_cndmask_b32 v18, 0, v56, vcc
    v_mov_b32 v19, v18
    v_mul_u32_u24 v28, 0xaaaa, v24
    v_add_u32 v28, 0x4444, v28
    v_lshlrev_b32 v61, 4, v20
    v_add_u32 v61, 147456, v61
    s_lshl_b32 s10, s3, 2
    v_add_u32 v60, s10, v61
    v_mov_b64 v[34:35], 0
    v_mov_b64 v[38:39], 0
    v_mov_b64 v[50:51], 0
    v_mov_b64 v[54:55], 0
    v_mov_b64 v[58:59], 0
    s_waitcnt lgkmcnt(0)
    s_bfe_u32 s10, s7, 0x30008
    s_lshl_b32 s16, s10, 7
    s_mul_i32 s22, s10, 196608
    s_mul_i32 s30, s10, 176128
    s_bfe_u32 s10, s7, 0x3000c
    s_lshl_b32 s17, s10, 7
    s_mul_i32 s23, s10, 196608
    s_mul_i32 s31, s10, 176128
    s_bfe_u32 s10, s7, 0x30010
    s_lshl_b32 s18, s10, 7
    s_mul_i32 s24, s10, 196608
    s_mul_i32 s32, s10, 176128
    s_bfe_u32 s10, s7, 0x30014
    s_lshl_b32 s19, s10, 7
    s_mul_i32 s25, s10, 196608
    s_mul_i32 s33, s10, 176128
    s_bfe_u32 s10, s7, 0x30018
    s_lshl_b32 s20, s10, 7
    s_mul_i32 s26, s10, 196608
    s_mul_i32 s34, s10, 176128
    s_bfe_u32 s10, s7, 0x3001c
    s_lshl_b32 s21, s10, 7
    s_mul_i32 s27, s10, 196608
    s_mul_i32 s35, s10, 176128
    v_and_b32 v70, 31, v0
    s_lshl_b32 s10, s93, 6
    v_lshl_add_u32 v31, v70, 1, s10
    s_add_u32 s10, s93, 0
    s_and_b32 s11, s10, 1
    s_mul_i32 s11, s11, 44
    s_lshr_b32 s10, s10, 1
    s_add_u32 s10, s10, s11
    s_lshl_b32 s10, s10, 6
    s_add_u32 s10, s10, s6
    s_lshl_b32 s84, s10, 10
    s_add_u32 s85, s84, 1441792
    s_add_u32 s10, s93, 1
    s_and_b32 s11, s10, 1
    s_mul_i32 s11, s11, 44
    s_lshr_b32 s10, s10, 1
    s_add_u32 s10, s10, s11
    s_lshl_b32 s10, s10, 6
    s_add_u32 s10, s10, s6
    s_lshl_b32 s86, s10, 10
    s_add_u32 s87, s86, 1441792
    s_add_u32 s10, s93, 2
    s_and_b32 s11, s10, 1
    s_mul_i32 s11, s11, 44
    s_lshr_b32 s10, s10, 1
    s_add_u32 s10, s10, s11
    s_lshl_b32 s10, s10, 6
    s_add_u32 s10, s10, s6
    s_lshl_b32 s36, s10, 10
    s_lshl_b32 s10, s4, 6
    s_add_u32 s10, s10, s6
    s_lshl_b32 s10, s10, 10
    s_add_u32 s10, s10, 5767168
    s_bitcmp1_b32 51968, s4
    s_cselect_b32 s36, s10, s36
    s_cselect_b32 s66, 0, 1409024
    s_mov_b64 s[64:65], s[48:49]
    s_add_u32 s37, s36, 1441792
    v_lshlrev_b32 v71, 5, v70
    v_accvgpr_write_b32 a130, v71
    s_lshl_b32 s12, s4, 4
    s_add_u32 s12, s12, s5
    s_mul_i32 s12, s12, 32
    s_add_u32 s12, s12, 6291456
    s_cmp_eq_u32 s3, 0
    s_cselect_b32 s12, s12, 8388608
    s_cselect_b32 s70, 0, 256
    s_cselect_b32 s71, 1, 0
    s_and_b32 s13, s4, 14
    s_xor_b32 s13, s13, 2
    s_mul_i32 s13, s13, 512
    s_add_u32 s13, s13, 6291456
    s_lshl_b32 s94, s4, 1
    s_and_b32 s97, s3, 1
    s_add_u32 s94, s94, s97
    s_lshl_b32 s94, s94, 17
    s_lshr_b32 s97, s3, 1
    s_lshl_b32 s97, s97, 16
    s_add_u32 s97, s97, s94
    s_add_u32 s97, s97, 4096
    v_add_u32 v71, s97, v1
    v_accvgpr_write_b32 a129, v71
    v_lshrrev_b32 v72, 5, v0
    v_lshlrev_b32 v71, 8, v72
    v_and_b32 v73, 15, v0
    v_lshl_add_u32 v71, v73, 4, v71
    v_add_u32 v71, s97, v71
    v_and_b32 v73, 27, v0
    v_cmp_eq_u32 vcc, 16, v73
    v_mov_b32 v73, 6557696
    v_mov_b32 v74, 6557712
    v_cndmask_b32 v73, v73, v74, vcc
    v_cndmask_b32 v71, v73, v71, s[88:89]
    v_accvgpr_write_b32 a128, v71
    v_mov_b32 v71, 0x2000
    v_cndmask_b32 v71, 0, v71, s[88:89]
    v_accvgpr_write_b32 a144, v71
    v_lshlrev_b32 v73, 2, v0
    s_lshl_b32 s97, s3, 8
    s_add_u32 s97, s97, 150528
    v_add_u32 v71, s97, v73
    v_accvgpr_write_b32 a131, v71
    s_and_b32 s97, s97, 0xfffffeff
    v_add_u32 v71, s97, v73
    v_accvgpr_write_b32 a132, v71
    s_lshl_b32 s97, s3, 10
    s_add_u32 s97, s97, 153600
    v_add_u32 v71, s97, v1
    v_accvgpr_write_b32 a133, v71
    s_and_b32 s97, s3, 1
    s_lshl_b32 s97, s97, 12
    s_add_u32 s97, s97, 153600
    v_add_u32 v73, s97, v1
    s_and_b32 s97, s3, 2
    s_lshl_b32 s97, s97, 10
    v_add_u32 v71, s97, v73
    v_accvgpr_write_b32 a135, v71
    s_xor_b32 s97, s97, 2048
    v_add_u32 v71, s97, v73
    v_accvgpr_write_b32 a134, v71
    v_add_u32 v71, s96, v1
    v_accvgpr_write_b32 a142, v71
    s_xor_b32 s97, s3, 2
    s_mul_i32 s97, s97, 40960
    v_add_u32 v71, s97, v1
    v_accvgpr_write_b32 a143, v71
    v_lshrrev_b32 v71, 3, v0
    v_and_b32 v73, 7, v0
    v_bfe_u32 v74, v0, 4, 1
    v_lshlrev_b32 v75, 2, v74
    v_xor_b32 v73, v73, v75
    v_lshlrev_b32 v73, 4, v73
    v_lshl_add_u32 v71, v71, 10, v73
    s_lshl_b32 s10, s3, 14
    s_lshl_b32 s11, s9, 7
    s_add_u32 s10, s10, s11
    v_add_u32 v71, s10, v71
    v_accvgpr_write_b32 a136, v71
    v_add_u32 v71, 7168, v71
    v_accvgpr_write_b32 a137, v71
    v_bfe_u32 v71, v0, 2, 2
    v_lshl_add_u32 v71, v72, 2, v71
    v_lshlrev_b32 v71, 7, v71
    v_lshl_add_u32 v71, v74, 5, v71
    v_and_b32 v73, 3, v0
    v_lshl_add_u32 v71, v73, 3, v71
    v_bfe_u32 v73, v0, 3, 1
    s_and_b32 s10, s3, 1
    v_xor_b32 v73, s10, v73
    v_lshl_add_u32 v71, v73, 6, v71
    v_add_u32 v71, s96, v71
    v_accvgpr_write_b32 a138, v71
    v_xor_b32 v71, 64, v71
    v_accvgpr_write_b32 a139, v71
    s_lshl_b32 s11, s9, 1
    s_add_u32 s11, s11, s10
    s_lshl_b32 s11, s11, 6
    s_lshl_b32 s97, s8, 1
    s_lshr_b32 s10, s3, 1
    s_add_u32 s97, s97, s10
    s_lshl_b32 s10, s97, 15
    s_add_u32 s9, s10, s11
    s_mul_i32 s11, s3, 1408
    s_add_u32 s97, s97, s11
    s_lshl_b32 s97, s97, 10
    v_add_u32 v71, s97, v1
    v_accvgpr_write_b32 a140, v71
    v_xor_b32 v71, 1024, v71
    v_accvgpr_write_b32 a141, v71
    s_mul_i32 s92, s8, 1024
    s_add_u32 s92, s92, 6356992
    s_and_b32 s8, s8, 3
    s_lshl_b32 s8, s8, 16
    s_and_b32 s10, s4, 1
    s_lshl_b32 s10, s10, 4
    s_lshr_b32 s11, s4, 1
    s_add_u32 s10, s10, s11
    s_lshl_b32 s10, s10, 6
    s_add_u32 s7, s10, s6
    s_lshl_b32 s7, s7, 10
    s_add_u32 s7, s7, 4194304
    s_and_b32 s10, s3, 1
    s_mul_i32 s10, s10, 523264
    s_add_u32 s93, s7, s10
    s_lshl_b32 s95, s6, 4
    s_add_u32 s95, s95, s4
    s_mul_i32 s95, s95, 32
    s_add_u32 s95, s95, 6356992
    s_xor_b32 s11, s11, 1
    s_lshl_b32 s11, s11, 8
    s_add_u32 s11, s11, s6
    s_lshl_b32 s5, s11, 11
    s_lshl_b32 s10, s6, 8
    s_add_u32 s10, s10, 6488064
    s_cmp_eq_u32 s4, 0
    s_cselect_b32 s6, s10, 8388608
    s_waitcnt lgkmcnt(0)
    s_add_u32 m0, s101, 57344
    s_nop 0
    buffer_load_dwordx4 v7, s[44:47], s39 offen offset:0  lds
    buffer_load_dwordx4 v8, s[44:47], s39 offen offset:1024  lds
    s_mov_b64 exec, 0
    s_cmp_eq_u32 s3, 1
    s_cbranch_scc1 L_pad1
    s_cmp_eq_u32 s3, 2
    s_cbranch_scc1 L_pad2
    s_cmp_eq_u32 s3, 3
    s_cbranch_scc1 L_pad3
    s_branch L_pad0
L_warm_back:
    s_mov_b64 exec, -1
    s_add_u32 m0, s100, 32768
    s_nop 0
    buffer_load_dwordx4 v3, s[40:43], s16 offen offset:0  lds
    buffer_load_dwordx4 v4, s[40:43], s16 offen offset:1024  lds
    buffer_load_dwordx4 v5, s[40:43], s16 offen offset:2048  lds
    buffer_load_dwordx4 v6, s[40:43], s16 offen offset:3072  lds
    s_add_u32 m0, s101, 65536
    s_nop 0
    buffer_load_dwordx4 v7, s[44:47], s22 offen offset:0  lds
    buffer_load_dwordx4 v8, s[44:47], s22 offen offset:1024  lds
    v_mov_b64 v[20:21], 0
    v_mov_b64 v[22:23], 0
    v_mov_b64 v[24:25], 0
    v_mov_b64 v[26:27], 0
    s_bitcmp1_b32 s4, 0
    s_cbranch_scc1 L_kvV
    s_branch L_main
L_exit:
    s_endpgm
.p2align 2
.type L_perm,@object
L_perm:
.long 0x36574210
.long 0x2317654
.long 0x16254037
.long 0x46357210
.long 0x21307654
.long 0x52614037
.long 0x65347210
.long 0x72310654
.long 0x2317654
.long 0x16254037
.long 0x36574210
.long 0x21307654
.long 0x42615037
.long 0x56347210
.long 0x72310654
.long 0x62514037
.long 0x16254037
.long 0x36574210
.long 0x2317654
.long 0x26154037
.long 0x46357210
.long 0x72310654
.long 0x52614037
.long 0x65347210
.long 0x36574210
.long 0x2317654
.long 0x16254037
.long 0x46357210
.long 0x21307654
.long 0x52614037
.long 0x65347210
.long 0x72310654
.p2align 12
L_main:
L_pad0:
    s_cbranch_execz L_pad4
    v_and_b32 v62, 0x33, v0
    v_bfe_u32 v52, v0, 2, 1
    v_lshl_or_b32 v62, v52, 3, v62
    v_bfe_u32 v52, v0, 3, 1
    v_lshl_or_b32 v62, v52, 2, v62
    v_lshlrev_b32 v62, 4, v62
    v_add_u32 v62, s5, v62
    s_waitcnt vmcnt(12)
    s_barrier
    ds_read_b128 v[192:195], v11 offset:0
    ds_read_b128 v[196:199], v12 offset:0
    ds_read_b128 v[200:203], v13 offset:0
    ds_read_b128 v[204:207], v14 offset:0
    ds_read_b64_tr_b16 a[72:73], v40 offset:0
    ds_read_b64_tr_b16 a[74:75], v40 offset:512
    ds_read_b64_tr_b16 a[76:77], v41 offset:0
    ds_read_b64_tr_b16 a[78:79], v41 offset:512
    ds_read_b64_tr_b16 a[80:81], v42 offset:0
    ds_read_b64_tr_b16 a[82:83], v42 offset:512
    ds_read_b64_tr_b16 a[84:85], v43 offset:0
    ds_read_b64_tr_b16 a[86:87], v43 offset:512
    s_waitcnt lgkmcnt(11)
    v_dot2c_f32_bf16 v15, v192, v192
    v_dot2c_f32_bf16 v15, v193, v193
    v_dot2c_f32_bf16 v15, v194, v194
    v_dot2c_f32_bf16 v15, v195, v195
    s_waitcnt lgkmcnt(10)
    v_dot2c_f32_bf16 v15, v196, v196
    v_dot2c_f32_bf16 v15, v197, v197
    v_dot2c_f32_bf16 v15, v198, v198
    v_dot2c_f32_bf16 v15, v199, v199
    s_waitcnt lgkmcnt(9)
    v_dot2c_f32_bf16 v15, v200, v200
    v_dot2c_f32_bf16 v15, v201, v201
    v_dot2c_f32_bf16 v15, v202, v202
    v_dot2c_f32_bf16 v15, v203, v203
    s_waitcnt lgkmcnt(8)
    v_dot2c_f32_bf16 v15, v204, v204
    v_dot2c_f32_bf16 v15, v205, v205
    v_dot2c_f32_bf16 v15, v206, v206
    v_dot2c_f32_bf16 v15, v207, v207
    s_waitcnt lgkmcnt(6)
    v_mfma_f32_32x32x16_bf16 v[64:79], a[72:75], v[192:195], 0
    s_add_u32 m0, s100, 0
    ds_read_b64_tr_b16 a[88:89], v44 offset:0
    buffer_load_dwordx4 v3, s[40:43], s17 offen offset:0  lds
    ds_read_b64_tr_b16 a[90:91], v44 offset:512
    s_waitcnt lgkmcnt(6)
    v_mfma_f32_32x32x16_bf16 v[80:95], a[76:79], v[192:195], 0
    buffer_load_dwordx4 v4, s[40:43], s17 offen offset:1024  lds
    ds_read_b64_tr_b16 a[92:93], v45 offset:0
    ds_read_b64_tr_b16 a[94:95], v45 offset:512
    v_smfmac_f32_16x16x64_bf16 v[24:27], v[16:19], a[72:79], v28
    ds_read_b64_tr_b16 a[96:97], v46 offset:0
    s_waitcnt lgkmcnt(7)
    v_mfma_f32_32x32x16_bf16 v[64:79], a[80:83], v[196:199], v[64:79]
    buffer_load_dwordx4 v5, s[40:43], s17 offen offset:2048  lds
    ds_read_b64_tr_b16 a[98:99], v46 offset:512
    ds_read_b64_tr_b16 a[100:101], v47 offset:0
    s_waitcnt lgkmcnt(7)
    v_mfma_f32_32x32x16_bf16 v[80:95], a[84:87], v[196:199], v[80:95]
    buffer_load_dwordx4 v6, s[40:43], s17 offen offset:3072  lds
    ds_read_b64_tr_b16 a[102:103], v47 offset:512
    s_waitcnt vmcnt(10)
    s_barrier
    v_smfmac_f32_16x16x64_bf16 v[20:23], v[16:19], v[192:199], v28
    s_add_u32 m0, s101, 73728
    ds_read_b128 v[208:211], v11 offset:16384
    s_waitcnt lgkmcnt(7)
    v_mfma_f32_32x32x16_bf16 v[64:79], a[88:91], v[200:203], v[64:79]
    buffer_load_dwordx4 v7, s[44:47], s23 offen offset:0  lds
    ds_read_b128 v[212:215], v12 offset:16384
    ds_read_b128 v[216:219], v13 offset:16384
    s_waitcnt lgkmcnt(7)
    v_mfma_f32_32x32x16_bf16 v[80:95], a[92:95], v[200:203], v[80:95]
    buffer_load_dwordx4 v8, s[44:47], s23 offen offset:1024  lds
    ds_read_b128 v[220:223], v14 offset:16384
    ds_read_b64_tr_b16 a[72:73], v40 offset:8192
    v_smfmac_f32_16x16x64_bf16 v[20:23], v[16:19], v[200:207], v28
    ds_read_b64_tr_b16 a[74:75], v40 offset:8704
    s_waitcnt lgkmcnt(8)
    v_mfma_f32_32x32x16_bf16 v[64:79], a[96:99], v[204:207], v[64:79]
    ds_read_b64_tr_b16 a[76:77], v41 offset:8192
    ds_read_b64_tr_b16 a[78:79], v41 offset:8704
    ds_read_b64_tr_b16 a[80:81], v42 offset:8192
    ds_read_b64_tr_b16 a[82:83], v42 offset:8704
    s_waitcnt lgkmcnt(10)
    v_mfma_f32_32x32x16_bf16 v[80:95], a[100:103], v[204:207], v[80:95]
    ds_read_b64_tr_b16 a[84:85], v43 offset:8192
    ds_read_b64_tr_b16 a[86:87], v43 offset:8704
    s_waitcnt lgkmcnt(8)
    v_dot2c_f32_bf16 v15, v223, v223
    v_dot2c_f32_bf16 v15, v222, v222
    v_dot2c_f32_bf16 v15, v221, v221
    v_dot2c_f32_bf16 v15, v220, v220
    v_dot2c_f32_bf16 v15, v219, v219
    v_dot2c_f32_bf16 v15, v218, v218
    v_dot2c_f32_bf16 v15, v217, v217
    v_dot2c_f32_bf16 v15, v216, v216
    v_dot2c_f32_bf16 v15, v215, v215
    v_dot2c_f32_bf16 v15, v214, v214
    v_dot2c_f32_bf16 v15, v213, v213
    v_dot2c_f32_bf16 v15, v212, v212
    v_dot2c_f32_bf16 v15, v211, v211
    v_dot2c_f32_bf16 v15, v210, v210
    v_dot2c_f32_bf16 v15, v209, v209
    v_dot2c_f32_bf16 v15, v208, v208
    s_waitcnt lgkmcnt(6)
    v_mfma_f32_32x32x16_bf16 v[64:79], a[72:75], v[208:211], v[64:79]
    s_add_u32 m0, s101, 81920
    ds_read_b64_tr_b16 a[88:89], v44 offset:8192
    buffer_load_dwordx4 v7, s[44:47], s24 offen offset:0  lds
    ds_read_b64_tr_b16 a[90:91], v44 offset:8704
    s_waitcnt lgkmcnt(6)
    v_mfma_f32_32x32x16_bf16 v[80:95], a[76:79], v[208:211], v[80:95]
    buffer_load_dwordx4 v8, s[44:47], s24 offen offset:1024  lds
    ds_read_b64_tr_b16 a[92:93], v45 offset:8192
    ds_read_b64_tr_b16 a[94:95], v45 offset:8704
    v_smfmac_f32_16x16x64_bf16 v[24:27], v[16:19], a[72:79], v28
    s_add_u32 m0, s100, 16384
    ds_read_b64_tr_b16 a[96:97], v46 offset:8192
    s_waitcnt lgkmcnt(7)
    v_mfma_f32_32x32x16_bf16 v[64:79], a[80:83], v[212:215], v[64:79]
    buffer_load_dwordx4 v3, s[40:43], s18 offen offset:0  lds
    ds_read_b64_tr_b16 a[98:99], v46 offset:8704
    ds_read_b64_tr_b16 a[100:101], v47 offset:8192
    s_waitcnt lgkmcnt(7)
    v_mfma_f32_32x32x16_bf16 v[80:95], a[84:87], v[212:215], v[80:95]
    buffer_load_dwordx4 v4, s[40:43], s18 offen offset:1024  lds
    ds_read_b64_tr_b16 a[102:103], v47 offset:8704
    s_waitcnt vmcnt(10)
    s_barrier
    v_smfmac_f32_16x16x64_bf16 v[20:23], v[16:19], v[208:215], v28
    ds_read_b128 v[224:227], v11 offset:32768
    s_waitcnt lgkmcnt(7)
    v_mfma_f32_32x32x16_bf16 v[64:79], a[88:91], v[216:219], v[64:79]
    buffer_load_dwordx4 v5, s[40:43], s18 offen offset:2048  lds
    ds_read_b128 v[228:231], v12 offset:32768
    ds_read_b128 v[232:235], v13 offset:32768
    s_waitcnt lgkmcnt(7)
    v_mfma_f32_32x32x16_bf16 v[80:95], a[92:95], v[216:219], v[80:95]
    buffer_load_dwordx4 v6, s[40:43], s18 offen offset:3072  lds
    ds_read_b128 v[236:239], v14 offset:32768
    ds_read_b64_tr_b16 a[72:73], v40 offset:16384
    v_smfmac_f32_16x16x64_bf16 v[20:23], v[16:19], v[216:223], v28
    ds_read_b64_tr_b16 a[74:75], v40 offset:16896
    s_waitcnt lgkmcnt(8)
    v_mfma_f32_32x32x16_bf16 v[64:79], a[96:99], v[220:223], v[64:79]
    ds_read_b64_tr_b16 a[76:77], v41 offset:16384
    ds_read_b64_tr_b16 a[78:79], v41 offset:16896
    ds_read_b64_tr_b16 a[80:81], v42 offset:16384
    ds_read_b64_tr_b16 a[82:83], v42 offset:16896
    s_waitcnt lgkmcnt(10)
    v_mfma_f32_32x32x16_bf16 v[80:95], a[100:103], v[220:223], v[80:95]
    ds_read_b64_tr_b16 a[84:85], v43 offset:16384
    ds_read_b64_tr_b16 a[86:87], v43 offset:16896
    s_waitcnt lgkmcnt(8)
    v_dot2c_f32_bf16 v15, v239, v239
    v_dot2c_f32_bf16 v15, v238, v238
    v_dot2c_f32_bf16 v15, v237, v237
    v_dot2c_f32_bf16 v15, v236, v236
    v_dot2c_f32_bf16 v15, v235, v235
    v_dot2c_f32_bf16 v15, v234, v234
    v_dot2c_f32_bf16 v15, v233, v233
    v_dot2c_f32_bf16 v15, v232, v232
    v_dot2c_f32_bf16 v15, v231, v231
    v_dot2c_f32_bf16 v15, v230, v230
    v_dot2c_f32_bf16 v15, v229, v229
    v_dot2c_f32_bf16 v15, v228, v228
    v_dot2c_f32_bf16 v15, v227, v227
    v_dot2c_f32_bf16 v15, v226, v226
    v_dot2c_f32_bf16 v15, v225, v225
    v_dot2c_f32_bf16 v15, v224, v224
    s_waitcnt lgkmcnt(6)
    v_mfma_f32_32x32x16_bf16 v[64:79], a[72:75], v[224:227], v[64:79]
    s_add_u32 m0, s101, 90112
    ds_read_b64_tr_b16 a[88:89], v44 offset:16384
    buffer_load_dwordx4 v7, s[44:47], s25 offen offset:0  lds
    ds_read_b64_tr_b16 a[90:91], v44 offset:16896
    s_waitcnt lgkmcnt(6)
    v_mfma_f32_32x32x16_bf16 v[80:95], a[76:79], v[224:227], v[80:95]
    buffer_load_dwordx4 v8, s[44:47], s25 offen offset:1024  lds
    ds_read_b64_tr_b16 a[92:93], v45 offset:16384
    ds_read_b64_tr_b16 a[94:95], v45 offset:16896
    v_smfmac_f32_16x16x64_bf16 v[24:27], v[16:19], a[72:79], v28
    s_add_u32 m0, s100, 32768
    ds_read_b64_tr_b16 a[96:97], v46 offset:16384
    s_waitcnt lgkmcnt(7)
    v_mfma_f32_32x32x16_bf16 v[64:79], a[80:83], v[228:231], v[64:79]
    buffer_load_dwordx4 v3, s[40:43], s19 offen offset:0  lds
    ds_read_b64_tr_b16 a[98:99], v46 offset:16896
    ds_read_b64_tr_b16 a[100:101], v47 offset:16384
    s_waitcnt lgkmcnt(7)
    v_mfma_f32_32x32x16_bf16 v[80:95], a[84:87], v[228:231], v[80:95]
    buffer_load_dwordx4 v4, s[40:43], s19 offen offset:1024  lds
    ds_read_b64_tr_b16 a[102:103], v47 offset:16896
    s_waitcnt vmcnt(10)
    s_barrier
    v_smfmac_f32_16x16x64_bf16 v[20:23], v[16:19], v[224:231], v28
    ds_read_b128 v[240:243], v11 offset:0
    s_waitcnt lgkmcnt(7)
    v_mfma_f32_32x32x16_bf16 v[64:79], a[88:91], v[232:235], v[64:79]
    buffer_load_dwordx4 v5, s[40:43], s19 offen offset:2048  lds
    ds_read_b128 v[244:247], v12 offset:0
    ds_read_b128 v[248:251], v13 offset:0
    s_waitcnt lgkmcnt(7)
    v_mfma_f32_32x32x16_bf16 v[80:95], a[92:95], v[232:235], v[80:95]
    buffer_load_dwordx4 v6, s[40:43], s19 offen offset:3072  lds
    ds_read_b128 v[252:255], v14 offset:0
    ds_read_b64_tr_b16 a[72:73], v40 offset:24576
    v_smfmac_f32_16x16x64_bf16 v[20:23], v[16:19], v[232:239], v28
    ds_read_b64_tr_b16 a[74:75], v40 offset:25088
    s_waitcnt lgkmcnt(8)
    v_mfma_f32_32x32x16_bf16 v[64:79], a[96:99], v[236:239], v[64:79]
    ds_read_b64_tr_b16 a[76:77], v41 offset:24576
    ds_read_b64_tr_b16 a[78:79], v41 offset:25088
    ds_read_b64_tr_b16 a[80:81], v42 offset:24576
    ds_read_b64_tr_b16 a[82:83], v42 offset:25088
    s_waitcnt lgkmcnt(10)
    v_mfma_f32_32x32x16_bf16 v[80:95], a[100:103], v[236:239], v[80:95]
    ds_read_b64_tr_b16 a[84:85], v43 offset:24576
    ds_read_b64_tr_b16 a[86:87], v43 offset:25088
    s_waitcnt lgkmcnt(8)
    v_dot2c_f32_bf16 v15, v255, v255
    v_dot2c_f32_bf16 v15, v254, v254
    v_dot2c_f32_bf16 v15, v253, v253
    v_dot2c_f32_bf16 v15, v252, v252
    v_dot2c_f32_bf16 v15, v251, v251
    v_dot2c_f32_bf16 v15, v250, v250
    v_dot2c_f32_bf16 v15, v249, v249
    v_dot2c_f32_bf16 v15, v248, v248
    v_dot2c_f32_bf16 v15, v247, v247
    v_dot2c_f32_bf16 v15, v246, v246
    v_dot2c_f32_bf16 v15, v245, v245
    v_dot2c_f32_bf16 v15, v244, v244
    v_dot2c_f32_bf16 v15, v243, v243
    v_dot2c_f32_bf16 v15, v242, v242
    v_dot2c_f32_bf16 v15, v241, v241
    v_dot2c_f32_bf16 v15, v240, v240
    s_waitcnt lgkmcnt(6)
    v_mfma_f32_32x32x16_bf16 v[64:79], a[72:75], v[240:243], v[64:79]
    s_add_u32 m0, s101, 98304
    ds_read_b64_tr_b16 a[88:89], v44 offset:24576
    buffer_load_dwordx4 v7, s[44:47], s26 offen offset:0  lds
    ds_read_b64_tr_b16 a[90:91], v44 offset:25088
    s_waitcnt lgkmcnt(6)
    v_mfma_f32_32x32x16_bf16 v[80:95], a[76:79], v[240:243], v[80:95]
    buffer_load_dwordx4 v8, s[44:47], s26 offen offset:1024  lds
    ds_read_b64_tr_b16 a[92:93], v45 offset:24576
    ds_read_b64_tr_b16 a[94:95], v45 offset:25088
    v_smfmac_f32_16x16x64_bf16 v[24:27], v[16:19], a[72:79], v28
    s_add_u32 m0, s101, 106496
    ds_read_b64_tr_b16 a[96:97], v46 offset:24576
    s_waitcnt lgkmcnt(7)
    v_mfma_f32_32x32x16_bf16 v[64:79], a[80:83], v[244:247], v[64:79]
    buffer_load_dwordx4 v7, s[44:47], s27 offen offset:0  lds
    ds_read_b64_tr_b16 a[98:99], v46 offset:25088
    ds_read_b64_tr_b16 a[100:101], v47 offset:24576
    s_waitcnt lgkmcnt(7)
    v_mfma_f32_32x32x16_bf16 v[80:95], a[84:87], v[244:247], v[80:95]
    buffer_load_dwordx4 v8, s[44:47], s27 offen offset:1024  lds
    ds_read_b64_tr_b16 a[102:103], v47 offset:25088
    s_waitcnt vmcnt(8)
    s_barrier
    v_smfmac_f32_16x16x64_bf16 v[20:23], v[16:19], v[240:247], v28
    s_add_u32 m0, s100, 0
    ds_read_b128 v[128:131], v11 offset:16384
    s_waitcnt lgkmcnt(7)
    v_mfma_f32_32x32x16_bf16 v[64:79], a[88:91], v[248:251], v[64:79]
    buffer_load_dwordx4 v3, s[40:43], s20 offen offset:0  lds
    ds_read_b128 v[132:135], v12 offset:16384
    ds_read_b128 v[136:139], v13 offset:16384
    s_waitcnt lgkmcnt(7)
    v_mfma_f32_32x32x16_bf16 v[80:95], a[92:95], v[248:251], v[80:95]
    buffer_load_dwordx4 v4, s[40:43], s20 offen offset:1024  lds
    ds_read_b128 v[140:143], v14 offset:16384
    ds_read_b64_tr_b16 a[72:73], v40 offset:32768
    v_smfmac_f32_16x16x64_bf16 v[20:23], v[16:19], v[248:255], v28
    ds_read_b64_tr_b16 a[74:75], v40 offset:33280
    s_waitcnt lgkmcnt(8)
    v_mfma_f32_32x32x16_bf16 v[64:79], a[96:99], v[252:255], v[64:79]
    buffer_load_dwordx4 v5, s[40:43], s20 offen offset:2048  lds
    ds_read_b64_tr_b16 a[76:77], v41 offset:32768
    ds_read_b64_tr_b16 a[78:79], v41 offset:33280
    s_waitcnt lgkmcnt(8)
    v_mfma_f32_32x32x16_bf16 v[80:95], a[100:103], v[252:255], v[80:95]
    buffer_load_dwordx4 v6, s[40:43], s20 offen offset:3072  lds
    ds_read_b64_tr_b16 a[80:81], v42 offset:32768
    ds_read_b64_tr_b16 a[82:83], v42 offset:33280
    ds_read_b64_tr_b16 a[84:85], v43 offset:32768
    ds_read_b64_tr_b16 a[86:87], v43 offset:33280
    s_waitcnt lgkmcnt(8)
    v_dot2c_f32_bf16 v15, v143, v143
    v_dot2c_f32_bf16 v15, v142, v142
    v_dot2c_f32_bf16 v15, v141, v141
    v_dot2c_f32_bf16 v15, v140, v140
    v_dot2c_f32_bf16 v15, v139, v139
    v_dot2c_f32_bf16 v15, v138, v138
    v_dot2c_f32_bf16 v15, v137, v137
    v_dot2c_f32_bf16 v15, v136, v136
    v_dot2c_f32_bf16 v15, v135, v135
    v_dot2c_f32_bf16 v15, v134, v134
    v_dot2c_f32_bf16 v15, v133, v133
    v_dot2c_f32_bf16 v15, v132, v132
    v_dot2c_f32_bf16 v15, v131, v131
    v_dot2c_f32_bf16 v15, v130, v130
    v_dot2c_f32_bf16 v15, v129, v129
    v_dot2c_f32_bf16 v15, v128, v128
    s_waitcnt lgkmcnt(6)
    v_mfma_f32_32x32x16_bf16 v[64:79], a[72:75], v[128:131], v[64:79]
    s_add_u32 m0, s100, 16384
    ds_read_b64_tr_b16 a[88:89], v44 offset:32768
    buffer_load_dwordx4 v3, s[40:43], s21 offen offset:0  lds
    ds_read_b64_tr_b16 a[90:91], v44 offset:33280
    s_waitcnt lgkmcnt(6)
    v_mfma_f32_32x32x16_bf16 v[80:95], a[76:79], v[128:131], v[80:95]
    buffer_load_dwordx4 v4, s[40:43], s21 offen offset:1024  lds
    ds_read_b64_tr_b16 a[92:93], v45 offset:32768
    ds_read_b64_tr_b16 a[94:95], v45 offset:33280
    v_smfmac_f32_16x16x64_bf16 v[24:27], v[16:19], a[72:79], v28
    ds_read_b64_tr_b16 a[96:97], v46 offset:32768
    s_waitcnt lgkmcnt(7)
    v_mfma_f32_32x32x16_bf16 v[64:79], a[80:83], v[132:135], v[64:79]
    buffer_load_dwordx4 v5, s[40:43], s21 offen offset:2048  lds
    ds_read_b64_tr_b16 a[98:99], v46 offset:33280
    ds_read_b64_tr_b16 a[100:101], v47 offset:32768
    s_waitcnt lgkmcnt(7)
    v_mfma_f32_32x32x16_bf16 v[80:95], a[84:87], v[132:135], v[80:95]
    buffer_load_dwordx4 v6, s[40:43], s21 offen offset:3072  lds
    ds_read_b64_tr_b16 a[102:103], v47 offset:33280
    s_waitcnt vmcnt(12)
    v_smfmac_f32_16x16x64_bf16 v[20:23], v[16:19], v[128:135], v28
    s_add_u32 m0, s100, 115712
    ds_read_b128 v[144:147], v11 offset:32768
    s_waitcnt lgkmcnt(7)
    v_mfma_f32_32x32x16_bf16 v[64:79], a[88:91], v[136:139], v[64:79]
    buffer_load_dwordx4 v10, s[48:51], s35 offen offset:0 lds
    ds_read_b128 v[148:151], v12 offset:32768
    ds_read_b128 v[152:155], v13 offset:32768
    s_waitcnt lgkmcnt(7)
    v_mfma_f32_32x32x16_bf16 v[80:95], a[92:95], v[136:139], v[80:95]
    s_add_u32 m0, s100, 116672
    ds_read_b128 v[156:159], v14 offset:32768
    buffer_load_dwordx4 v10, s[48:51], s35 offen offset:64 lds
    ds_read_b64_tr_b16 a[72:73], v40 offset:40960
    v_smfmac_f32_16x16x64_bf16 v[20:23], v[16:19], v[136:143], v28
    s_add_u32 m0, s100, 117632
    ds_read_b64_tr_b16 a[74:75], v40 offset:41472
    s_waitcnt lgkmcnt(8)
    v_mfma_f32_32x32x16_bf16 v[64:79], a[96:99], v[140:143], v[64:79]
    buffer_load_dwordx4 v10, s[64:67], s35 offen offset:128 lds
    ds_read_b64_tr_b16 a[76:77], v41 offset:40960
    ds_read_b64_tr_b16 a[78:79], v41 offset:41472
    s_waitcnt lgkmcnt(8)
    v_mfma_f32_32x32x16_bf16 v[80:95], a[100:103], v[140:143], v[80:95]
    s_add_u32 m0, s100, 114688
    ds_read_b64_tr_b16 a[80:81], v42 offset:40960
    buffer_load_dwordx4 v9, s[44:47], s27 offen lds
    ds_read_b64_tr_b16 a[82:83], v42 offset:41472
    ds_read_b64_tr_b16 a[84:85], v43 offset:40960
    ds_read_b64_tr_b16 a[86:87], v43 offset:41472
    s_waitcnt lgkmcnt(8)
    v_dot2c_f32_bf16 v15, v159, v159
    v_dot2c_f32_bf16 v15, v158, v158
    v_dot2c_f32_bf16 v15, v157, v157
    v_dot2c_f32_bf16 v15, v156, v156
    v_dot2c_f32_bf16 v15, v155, v155
    v_dot2c_f32_bf16 v15, v154, v154
    v_dot2c_f32_bf16 v15, v153, v153
    v_dot2c_f32_bf16 v15, v152, v152
    v_dot2c_f32_bf16 v15, v151, v151
    v_dot2c_f32_bf16 v15, v150, v150
    v_dot2c_f32_bf16 v15, v149, v149
    v_dot2c_f32_bf16 v15, v148, v148
    v_dot2c_f32_bf16 v15, v147, v147
    v_dot2c_f32_bf16 v15, v146, v146
    v_dot2c_f32_bf16 v15, v145, v145
    v_dot2c_f32_bf16 v15, v144, v144
    s_waitcnt lgkmcnt(6)
    v_mfma_f32_32x32x16_bf16 v[64:79], a[72:75], v[144:147], v[64:79]
    buffer_load_ushort v29, v31, s[76:79], 0 offen offset:0
    ds_read_b64_tr_b16 a[88:89], v44 offset:40960
    ds_read_b64_tr_b16 a[90:91], v44 offset:41472
    s_waitcnt lgkmcnt(6)
    v_mfma_f32_32x32x16_bf16 v[80:95], a[76:79], v[144:147], v[80:95]
    buffer_load_ushort v30, v31, s[76:79], 0 offen offset:64
    ds_read_b64_tr_b16 a[92:93], v45 offset:40960
    ds_read_b64_tr_b16 a[94:95], v45 offset:41472
    v_smfmac_f32_16x16x64_bf16 v[24:27], v[16:19], a[72:79], v28
    ds_read_b64_tr_b16 a[96:97], v46 offset:40960
    s_waitcnt lgkmcnt(7)
    v_mfma_f32_32x32x16_bf16 v[64:79], a[80:83], v[148:151], v[64:79]
    buffer_load_ushort v31, v31, s[76:79], 0 offen offset:128
    ds_read_b64_tr_b16 a[98:99], v46 offset:41472
    ds_read_b64_tr_b16 a[100:101], v47 offset:40960
    s_waitcnt lgkmcnt(7)
    v_mfma_f32_32x32x16_bf16 v[80:95], a[84:87], v[148:151], v[80:95]
    global_load_dword a160, v1, s[80:81]
    ds_read_b64_tr_b16 a[102:103], v47 offset:41472
    s_waitcnt vmcnt(12)
    s_barrier
    s_lshl_b32 s10, s3, 8
    s_add_u32 s10, s10, s2
    s_sub_u32 s10, s10, 176
    s_cmp_ge_u32 s10, 16
    s_cbranch_scc1 L_nogo0
    v_mov_b32 v52, 1
    s_lshl_b32 s10, s10, 4
    s_mov_b64 exec, 1
    buffer_store_dword v52, v50, s[72:75], s10 offen sc1
    s_mov_b64 exec, -1
L_nogo0:
    v_smfmac_f32_16x16x64_bf16 v[20:23], v[16:19], v[144:151], v28
    ds_read_b128 v[160:163], v11 offset:0
    s_waitcnt lgkmcnt(7)
    v_mfma_f32_32x32x16_bf16 v[64:79], a[88:91], v[152:155], v[64:79]
    ds_read_b128 v[164:167], v12 offset:0
    ds_read_b128 v[168:171], v13 offset:0
    ds_read_b128 v[172:175], v14 offset:0
    ds_read_b64_tr_b16 a[72:73], v40 offset:49152
    s_waitcnt lgkmcnt(9)
    v_mfma_f32_32x32x16_bf16 v[80:95], a[92:95], v[152:155], v[80:95]
    ds_read_b64_tr_b16 a[74:75], v40 offset:49664
    ds_read_b64_tr_b16 a[76:77], v41 offset:49152
    ds_read_b64_tr_b16 a[78:79], v41 offset:49664
    ds_read_b64_tr_b16 a[80:81], v42 offset:49152
    v_smfmac_f32_16x16x64_bf16 v[20:23], v[16:19], v[152:159], v28
    ds_read_b64_tr_b16 a[82:83], v42 offset:49664
    s_waitcnt lgkmcnt(12)
    v_mfma_f32_32x32x16_bf16 v[64:79], a[96:99], v[156:159], v[64:79]
    ds_read_b64_tr_b16 a[84:85], v43 offset:49152
    ds_read_b64_tr_b16 a[86:87], v43 offset:49664
    s_waitcnt lgkmcnt(12)
    v_mfma_f32_32x32x16_bf16 v[80:95], a[100:103], v[156:159], v[80:95]
    s_waitcnt lgkmcnt(8)
    v_dot2c_f32_bf16 v15, v175, v175
    v_dot2c_f32_bf16 v15, v174, v174
    v_dot2c_f32_bf16 v15, v173, v173
    v_dot2c_f32_bf16 v15, v172, v172
    v_dot2c_f32_bf16 v15, v171, v171
    v_dot2c_f32_bf16 v15, v170, v170
    v_dot2c_f32_bf16 v15, v169, v169
    v_dot2c_f32_bf16 v15, v168, v168
    v_dot2c_f32_bf16 v15, v167, v167
    v_dot2c_f32_bf16 v15, v166, v166
    v_dot2c_f32_bf16 v15, v165, v165
    v_dot2c_f32_bf16 v15, v164, v164
    v_dot2c_f32_bf16 v15, v163, v163
    v_dot2c_f32_bf16 v15, v162, v162
    v_dot2c_f32_bf16 v15, v161, v161
    v_dot2c_f32_bf16 v15, v160, v160
    s_waitcnt lgkmcnt(6)
    v_mfma_f32_32x32x16_bf16 v[64:79], a[72:75], v[160:163], v[64:79]
    s_add_u32 m0, s100, 132096
    ds_read_b64_tr_b16 a[88:89], v44 offset:49152
    buffer_load_dwordx4 v10, s[48:51], s28 offen offset:0 lds
    ds_read_b64_tr_b16 a[90:91], v44 offset:49664
    s_waitcnt lgkmcnt(6)
    v_mfma_f32_32x32x16_bf16 v[80:95], a[76:79], v[160:163], v[80:95]
    s_add_u32 m0, s100, 133056
    ds_read_b64_tr_b16 a[92:93], v45 offset:49152
    buffer_load_dwordx4 v10, s[48:51], s28 offen offset:64 lds
    ds_read_b64_tr_b16 a[94:95], v45 offset:49664
    v_smfmac_f32_16x16x64_bf16 v[24:27], v[16:19], a[72:79], v28
    s_add_u32 m0, s100, 134016
    ds_read_b64_tr_b16 a[96:97], v46 offset:49152
    s_waitcnt lgkmcnt(7)
    v_mfma_f32_32x32x16_bf16 v[64:79], a[80:83], v[164:167], v[64:79]
    buffer_load_dwordx4 v10, s[64:67], s28 offen offset:128 lds
    ds_read_b64_tr_b16 a[98:99], v46 offset:49664
    ds_read_b64_tr_b16 a[100:101], v47 offset:49152
    s_waitcnt lgkmcnt(7)
    v_mfma_f32_32x32x16_bf16 v[80:95], a[84:87], v[164:167], v[80:95]
    ds_read_b64_tr_b16 a[102:103], v47 offset:49664
    s_waitcnt vmcnt(11)
    ds_read_b128 v[176:179], v11 offset:16384
    ds_read_b128 v[180:183], v12 offset:16384
    v_smfmac_f32_16x16x64_bf16 v[20:23], v[16:19], v[160:167], v28
    ds_read_b128 v[184:187], v13 offset:16384
    s_waitcnt lgkmcnt(9)
    v_mfma_f32_32x32x16_bf16 v[64:79], a[88:91], v[168:171], v[64:79]
    ds_read_b128 v[188:191], v14 offset:16384
    ds_read_b64_tr_b16 a[72:73], v40 offset:57344
    ds_read_b64_tr_b16 a[74:75], v40 offset:57856
    ds_read_b64_tr_b16 a[76:77], v41 offset:57344
    s_waitcnt lgkmcnt(11)
    v_mfma_f32_32x32x16_bf16 v[80:95], a[92:95], v[168:171], v[80:95]
    ds_read_b64_tr_b16 a[78:79], v41 offset:57856
    ds_read_b64_tr_b16 a[80:81], v42 offset:57344
    ds_read_b64_tr_b16 a[82:83], v42 offset:57856
    ds_read_b64_tr_b16 a[84:85], v43 offset:57344
    v_smfmac_f32_16x16x64_bf16 v[20:23], v[16:19], v[168:175], v28
    ds_read_b64_tr_b16 a[86:87], v43 offset:57856
    s_waitcnt lgkmcnt(14)
    v_mfma_f32_32x32x16_bf16 v[64:79], a[96:99], v[172:175], v[64:79]
    s_waitcnt lgkmcnt(12)
    v_mfma_f32_32x32x16_bf16 v[80:95], a[100:103], v[172:175], v[80:95]
    s_waitcnt lgkmcnt(8)
    v_dot2c_f32_bf16 v15, v191, v191
    v_dot2c_f32_bf16 v15, v190, v190
    v_dot2c_f32_bf16 v15, v189, v189
    v_dot2c_f32_bf16 v15, v188, v188
    v_dot2c_f32_bf16 v15, v187, v187
    v_dot2c_f32_bf16 v15, v186, v186
    v_dot2c_f32_bf16 v15, v185, v185
    v_dot2c_f32_bf16 v15, v184, v184
    v_dot2c_f32_bf16 v15, v183, v183
    v_dot2c_f32_bf16 v15, v182, v182
    v_dot2c_f32_bf16 v15, v181, v181
    v_dot2c_f32_bf16 v15, v180, v180
    v_dot2c_f32_bf16 v15, v179, v179
    v_dot2c_f32_bf16 v15, v178, v178
    v_dot2c_f32_bf16 v15, v177, v177
    v_dot2c_f32_bf16 v15, v176, v176
    s_waitcnt lgkmcnt(4)
    v_smfmac_f32_16x16x64_bf16 v[24:27], v[16:19], a[72:79], v28
    s_add_u32 m0, s100, 131072
    ds_read_b64_tr_b16 a[88:89], v44 offset:57344
    v_smfmac_f32_16x16x64_bf16 v[20:23], v[16:19], v[176:183], v28
    ds_read_b64_tr_b16 a[90:91], v44 offset:57856
    v_smfmac_f32_16x16x64_bf16 v[20:23], v[16:19], v[184:191], v28
    ds_read_b64_tr_b16 a[92:93], v45 offset:57344
    v_mfma_f32_32x32x16_bf16 v[64:79], a[72:75], v[176:179], v[64:79]
    buffer_load_dwordx4 v9, s[44:47], s38 offen lds
    ds_read_b64_tr_b16 a[94:95], v45 offset:57856
    ds_read_b64_tr_b16 a[96:97], v46 offset:57344
    ds_read_b64_tr_b16 a[98:99], v46 offset:57856
    ds_read_b64_tr_b16 a[100:101], v47 offset:57344
    v_mfma_f32_32x32x16_bf16 v[80:95], a[76:79], v[176:179], v[80:95]
    s_add_u32 m0, s100, 33792
    ds_read_b64_tr_b16 a[102:103], v47 offset:57856
    buffer_load_dwordx4 v10, s[48:51], s29 offen offset:0 lds
    v_add_f32 v24, v24, v25
    v_add_f32 v26, v26, v27
    ds_write_b32 v60, v24 offset:0
    s_waitcnt lgkmcnt(11)
    v_mfma_f32_32x32x16_bf16 v[64:79], a[80:83], v[180:183], v[64:79]
    s_add_u32 m0, s100, 34752
    ds_write_b32 v60, v26 offset:512
    buffer_load_dwordx4 v10, s[48:51], s29 offen offset:64 lds
    v_add_f32 v20, v20, v21
    v_add_f32 v22, v22, v23
    v_add_f32 v20, v20, v22
    s_waitcnt lgkmcnt(10)
    v_mfma_f32_32x32x16_bf16 v[80:95], a[84:87], v[180:183], v[80:95]
    s_add_u32 m0, s100, 35712
    v_mov_b32 v53, v15
    buffer_load_dwordx4 v10, s[64:67], s29 offen offset:128 lds
    s_nop 0
    v_permlane32_swap_b32 v15, v53
    v_add_f32 v15, v15, v53
    v_mul_f32 v15, 0x3b000000, v15
    s_waitcnt lgkmcnt(8)
    v_mfma_f32_32x32x16_bf16 v[64:79], a[88:91], v[184:187], v[64:79]
    s_add_u32 m0, s100, 32768
    v_mul_f32 v20, 0xbb000000, v20
    buffer_load_dwordx4 v9, s[44:47], s39 offen lds
    v_fma_f32 v21, -v20, v20, v15
    v_max_f32 v21, 0, v21
    v_add_f32 v21, 0x3727c5ac, v21
    s_waitcnt lgkmcnt(6)
    v_mfma_f32_32x32x16_bf16 v[80:95], a[92:95], v[184:187], v[80:95]
    v_rsq_f32 v22, v21
    s_waitcnt lgkmcnt(0)
    s_barrier
    ds_read_b128 v[96:99], v61 offset:0
    ds_read_b128 v[100:103], v61 offset:512
    v_mul_f32 v21, v21, v22
    v_cndmask_b32 v52, v20, v21, s[90:91]
    v_mfma_f32_32x32x16_bf16 v[64:79], a[96:99], v[188:191], v[64:79]
    v_and_b32 v53, 0xffff0000, v52
    v_sub_f32 v52, v52, v53
    v_cvt_pk_bf16_f32 v48, v53, v52
    v_cndmask_b32 v49, v48, 0, s[90:91]
    s_waitcnt lgkmcnt(1)
    v_add_f32 v96, v96, v98
    v_add_f32 v97, v97, v99
    v_mfma_f32_32x32x16_bf16 v[80:95], a[100:103], v[188:191], v[80:95]
    v_add_f32 v96, v96, v97
    v_and_b32 v97, 0xffff0000, v96
    v_sub_f32 v98, v96, v97
    v_cvt_pk_bf16_f32 v97, v97, v97
    v_cvt_pk_bf16_f32 v98, v98, v98
    v_cndmask_b32 v32, v97, 0, s[90:91]
    v_cndmask_b32 v33, v98, 0, s[90:91]
    s_waitcnt lgkmcnt(0)
    v_add_f32 v100, v100, v102
    v_add_f32 v101, v101, v103
    v_add_f32 v100, v100, v101
    v_and_b32 v101, 0xffff0000, v100
    v_sub_f32_e64 v102, v100, v101
    v_cvt_pk_bf16_f32 v101, v101, v101
    v_cvt_pk_bf16_f32 v102, v102, v102
    v_cndmask_b32 v36, v101, 0, s[90:91]
    v_cndmask_b32 v37, v102, 0, s[90:91]
    v_mov_b32 v23, v22
    v_mfma_f32_32x32x16_bf16 v[64:79], v[32:35], v[48:51], v[64:79]
    v_mfma_f32_32x32x16_bf16 v[80:95], v[36:39], v[48:51], v[80:95]
    v_mul_f32 v3, v22, v22
    v_lshlrev_b32 v11, 2, v0
    v_add_u32 v4, 131072, v62
    v_add_u32 v5, 262144, v62
    v_add_u32 v6, 393216, v62
    v_mov_b64 v[24:25], 0
    v_mov_b64 v[26:27], 0
    v_mov_b64 v[32:33], 0
    v_xor_b32_e64 v40, 0, v63
    v_xor_b32 v41, 4096, v63
    v_xor_b32 v42, 8192, v63
    v_xor_b32 v43, 12288, v63
    v_add_u32 v44, 81920, v40
    v_add_u32 v45, 81920, v41
    v_add_u32 v46, 81920, v42
    v_add_u32 v47, 81920, v43
    v_pk_mul_f32 v[64:65], v[64:65], v[22:23]
    v_pk_mul_f32 v[66:67], v[66:67], v[22:23]
    v_pk_mul_f32 v[68:69], v[68:69], v[22:23]
    v_pk_mul_f32 v[70:71], v[70:71], v[22:23]
    v_cvt_pk_bf16_f32 v52, v64, v65
    v_cvt_pk_bf16_f32 v53, v66, v67
    v_cvt_pk_bf16_f32 v54, v68, v69
    v_cvt_pk_bf16_f32 v55, v70, v71
    global_store_dwordx4 v62, v[52:55], s[60:61] sc1
    v_pk_mul_f32 v[72:73], v[72:73], v[22:23]
    v_pk_mul_f32 v[74:75], v[74:75], v[22:23]
    v_pk_mul_f32 v[76:77], v[76:77], v[22:23]
    v_pk_mul_f32 v[78:79], v[78:79], v[22:23]
    v_cvt_pk_bf16_f32 v56, v72, v73
    v_cvt_pk_bf16_f32 v57, v74, v75
    v_cvt_pk_bf16_f32 v58, v76, v77
    v_cvt_pk_bf16_f32 v59, v78, v79
    global_store_dwordx4 v4, v[56:59], s[60:61] sc1
    v_pk_mul_f32 v[80:81], v[80:81], v[22:23]
    v_pk_mul_f32 v[82:83], v[82:83], v[22:23]
    v_pk_mul_f32 v[84:85], v[84:85], v[22:23]
    v_pk_mul_f32 v[86:87], v[86:87], v[22:23]
    v_cvt_pk_bf16_f32 v36, v80, v81
    v_cvt_pk_bf16_f32 v37, v82, v83
    v_cvt_pk_bf16_f32 v38, v84, v85
    v_cvt_pk_bf16_f32 v39, v86, v87
    global_store_dwordx4 v5, v[36:39], s[60:61] sc1
L_pad1:
    s_cbranch_execz L_pad5
    s_nop 0
    v_pk_mul_f32 v[88:89], v[88:89], v[22:23]
    v_pk_mul_f32 v[90:91], v[90:91], v[22:23]
    v_pk_mul_f32 v[92:93], v[92:93], v[22:23]
    v_pk_mul_f32 v[94:95], v[94:95], v[22:23]
    v_cvt_pk_bf16_f32 v12, v88, v89
    v_cvt_pk_bf16_f32 v13, v90, v91
    v_cvt_pk_bf16_f32 v14, v92, v93
    v_cvt_pk_bf16_f32 v15, v94, v95
    global_store_dwordx4 v6, v[12:15], s[60:61] sc1
    buffer_store_dword v3, v11, s[60:63], s6 offen sc1
    s_branch L_kvdone
L_kvV:
    v_bfe_u32 v62, v0, 4, 1
    v_lshlrev_b32 v62, 17, v62
    v_lshrrev_b32 v52, 5, v0
    v_lshl_add_u32 v62, v52, 8, v62
    v_and_b32 v52, 15, v0
    v_lshl_add_u32 v62, v52, 4, v62
    v_add_u32_e64 v62, s5, v62
    s_waitcnt vmcnt(12)
    s_barrier
    ds_read_b128 v[192:195], v11 offset:0
    ds_read_b128 v[196:199], v12 offset:0
    ds_read_b128 v[200:203], v13 offset:0
    ds_read_b128 v[204:207], v14 offset:0
    ds_read_b64_tr_b16 a[72:73], v40 offset:0
    ds_read_b64_tr_b16 a[74:75], v40 offset:512
    ds_read_b64_tr_b16 a[76:77], v41 offset:0
    ds_read_b64_tr_b16 a[78:79], v41 offset:512
    ds_read_b64_tr_b16 a[80:81], v42 offset:0
    ds_read_b64_tr_b16 a[82:83], v42 offset:512
    ds_read_b64_tr_b16 a[84:85], v43 offset:0
    ds_read_b64_tr_b16 a[86:87], v43 offset:512
    s_waitcnt lgkmcnt(11)
    v_dot2c_f32_bf16 v15, v192, v192
    v_dot2c_f32_bf16 v15, v193, v193
    v_dot2c_f32_bf16 v15, v194, v194
    v_dot2c_f32_bf16 v15, v195, v195
    s_waitcnt lgkmcnt(10)
    v_dot2c_f32_bf16 v15, v196, v196
    v_dot2c_f32_bf16 v15, v197, v197
    v_dot2c_f32_bf16 v15, v198, v198
    v_dot2c_f32_bf16 v15, v199, v199
    s_waitcnt lgkmcnt(9)
    v_dot2c_f32_bf16 v15, v200, v200
    v_dot2c_f32_bf16 v15, v201, v201
    v_dot2c_f32_bf16 v15, v202, v202
    v_dot2c_f32_bf16 v15, v203, v203
    s_waitcnt lgkmcnt(8)
    v_dot2c_f32_bf16 v15, v204, v204
    v_dot2c_f32_bf16 v15, v205, v205
    v_dot2c_f32_bf16 v15, v206, v206
    v_dot2c_f32_bf16 v15, v207, v207
    s_waitcnt lgkmcnt(6)
    v_mfma_f32_32x32x16_bf16 v[64:79], v[192:195], a[72:75], 0
    s_add_u32 m0, s100, 0
    ds_read_b64_tr_b16 a[88:89], v44 offset:0
    buffer_load_dwordx4 v3, s[40:43], s17 offen offset:0  lds
    ds_read_b64_tr_b16 a[90:91], v44 offset:512
    s_waitcnt lgkmcnt(6)
    v_mfma_f32_32x32x16_bf16 v[80:95], v[192:195], a[76:79], 0
    buffer_load_dwordx4 v4, s[40:43], s17 offen offset:1024  lds
    ds_read_b64_tr_b16 a[92:93], v45 offset:0
    ds_read_b64_tr_b16 a[94:95], v45 offset:512
    v_smfmac_f32_16x16x64_bf16 v[24:27], v[16:19], a[72:79], v28
    ds_read_b64_tr_b16 a[96:97], v46 offset:0
    s_waitcnt lgkmcnt(7)
    v_mfma_f32_32x32x16_bf16 v[64:79], v[196:199], a[80:83], v[64:79]
    buffer_load_dwordx4 v5, s[40:43], s17 offen offset:2048  lds
    ds_read_b64_tr_b16 a[98:99], v46 offset:512
    ds_read_b64_tr_b16 a[100:101], v47 offset:0
    s_waitcnt lgkmcnt(7)
    v_mfma_f32_32x32x16_bf16 v[80:95], v[196:199], a[84:87], v[80:95]
    buffer_load_dwordx4 v6, s[40:43], s17 offen offset:3072  lds
    ds_read_b64_tr_b16 a[102:103], v47 offset:512
    s_waitcnt vmcnt(10)
    s_barrier
    v_smfmac_f32_16x16x64_bf16 v[20:23], v[16:19], v[192:199], v28
    s_add_u32 m0, s101, 73728
    ds_read_b128 v[208:211], v11 offset:16384
    s_waitcnt lgkmcnt(7)
    v_mfma_f32_32x32x16_bf16 v[64:79], v[200:203], a[88:91], v[64:79]
    buffer_load_dwordx4 v7, s[44:47], s23 offen offset:0  lds
    ds_read_b128 v[212:215], v12 offset:16384
    ds_read_b128 v[216:219], v13 offset:16384
    s_waitcnt lgkmcnt(7)
    v_mfma_f32_32x32x16_bf16 v[80:95], v[200:203], a[92:95], v[80:95]
    buffer_load_dwordx4 v8, s[44:47], s23 offen offset:1024  lds
    ds_read_b128 v[220:223], v14 offset:16384
    ds_read_b64_tr_b16 a[72:73], v40 offset:8192
    v_smfmac_f32_16x16x64_bf16 v[20:23], v[16:19], v[200:207], v28
    ds_read_b64_tr_b16 a[74:75], v40 offset:8704
    s_waitcnt lgkmcnt(8)
    v_mfma_f32_32x32x16_bf16 v[64:79], v[204:207], a[96:99], v[64:79]
    ds_read_b64_tr_b16 a[76:77], v41 offset:8192
    ds_read_b64_tr_b16 a[78:79], v41 offset:8704
    ds_read_b64_tr_b16 a[80:81], v42 offset:8192
    ds_read_b64_tr_b16 a[82:83], v42 offset:8704
    s_waitcnt lgkmcnt(10)
    v_mfma_f32_32x32x16_bf16 v[80:95], v[204:207], a[100:103], v[80:95]
    ds_read_b64_tr_b16 a[84:85], v43 offset:8192
    ds_read_b64_tr_b16 a[86:87], v43 offset:8704
    s_waitcnt lgkmcnt(8)
    v_dot2c_f32_bf16 v15, v223, v223
    v_dot2c_f32_bf16 v15, v222, v222
    v_dot2c_f32_bf16 v15, v221, v221
    v_dot2c_f32_bf16 v15, v220, v220
    v_dot2c_f32_bf16 v15, v219, v219
    v_dot2c_f32_bf16 v15, v218, v218
    v_dot2c_f32_bf16 v15, v217, v217
    v_dot2c_f32_bf16 v15, v216, v216
    v_dot2c_f32_bf16 v15, v215, v215
    v_dot2c_f32_bf16 v15, v214, v214
    v_dot2c_f32_bf16 v15, v213, v213
    v_dot2c_f32_bf16 v15, v212, v212
    v_dot2c_f32_bf16 v15, v211, v211
    v_dot2c_f32_bf16 v15, v210, v210
    v_dot2c_f32_bf16 v15, v209, v209
    v_dot2c_f32_bf16 v15, v208, v208
    s_waitcnt lgkmcnt(6)
    v_mfma_f32_32x32x16_bf16 v[64:79], v[208:211], a[72:75], v[64:79]
    s_add_u32 m0, s101, 81920
    ds_read_b64_tr_b16 a[88:89], v44 offset:8192
    buffer_load_dwordx4 v7, s[44:47], s24 offen offset:0  lds
    ds_read_b64_tr_b16 a[90:91], v44 offset:8704
    s_waitcnt lgkmcnt(6)
    v_mfma_f32_32x32x16_bf16 v[80:95], v[208:211], a[76:79], v[80:95]
    buffer_load_dwordx4 v8, s[44:47], s24 offen offset:1024  lds
    ds_read_b64_tr_b16 a[92:93], v45 offset:8192
    ds_read_b64_tr_b16 a[94:95], v45 offset:8704
    v_smfmac_f32_16x16x64_bf16 v[24:27], v[16:19], a[72:79], v28
    s_add_u32 m0, s100, 16384
    ds_read_b64_tr_b16 a[96:97], v46 offset:8192
    s_waitcnt lgkmcnt(7)
    v_mfma_f32_32x32x16_bf16 v[64:79], v[212:215], a[80:83], v[64:79]
    buffer_load_dwordx4 v3, s[40:43], s18 offen offset:0  lds
    ds_read_b64_tr_b16 a[98:99], v46 offset:8704
    ds_read_b64_tr_b16 a[100:101], v47 offset:8192
    s_waitcnt lgkmcnt(7)
    v_mfma_f32_32x32x16_bf16 v[80:95], v[212:215], a[84:87], v[80:95]
    buffer_load_dwordx4 v4, s[40:43], s18 offen offset:1024  lds
    ds_read_b64_tr_b16 a[102:103], v47 offset:8704
    s_waitcnt vmcnt(10)
    s_barrier
    v_smfmac_f32_16x16x64_bf16 v[20:23], v[16:19], v[208:215], v28
    ds_read_b128 v[224:227], v11 offset:32768
    s_waitcnt lgkmcnt(7)
    v_mfma_f32_32x32x16_bf16 v[64:79], v[216:219], a[88:91], v[64:79]
    buffer_load_dwordx4 v5, s[40:43], s18 offen offset:2048  lds
    ds_read_b128 v[228:231], v12 offset:32768
    ds_read_b128 v[232:235], v13 offset:32768
    s_waitcnt lgkmcnt(7)
    v_mfma_f32_32x32x16_bf16 v[80:95], v[216:219], a[92:95], v[80:95]
    buffer_load_dwordx4 v6, s[40:43], s18 offen offset:3072  lds
    ds_read_b128 v[236:239], v14 offset:32768
    ds_read_b64_tr_b16 a[72:73], v40 offset:16384
    v_smfmac_f32_16x16x64_bf16 v[20:23], v[16:19], v[216:223], v28
    ds_read_b64_tr_b16 a[74:75], v40 offset:16896
    s_waitcnt lgkmcnt(8)
    v_mfma_f32_32x32x16_bf16 v[64:79], v[220:223], a[96:99], v[64:79]
    ds_read_b64_tr_b16 a[76:77], v41 offset:16384
    ds_read_b64_tr_b16 a[78:79], v41 offset:16896
    ds_read_b64_tr_b16 a[80:81], v42 offset:16384
    ds_read_b64_tr_b16 a[82:83], v42 offset:16896
    s_waitcnt lgkmcnt(10)
    v_mfma_f32_32x32x16_bf16 v[80:95], v[220:223], a[100:103], v[80:95]
    ds_read_b64_tr_b16 a[84:85], v43 offset:16384
    ds_read_b64_tr_b16 a[86:87], v43 offset:16896
    s_waitcnt lgkmcnt(8)
    v_dot2c_f32_bf16 v15, v239, v239
    v_dot2c_f32_bf16 v15, v238, v238
    v_dot2c_f32_bf16 v15, v237, v237
    v_dot2c_f32_bf16 v15, v236, v236
    v_dot2c_f32_bf16 v15, v235, v235
    v_dot2c_f32_bf16 v15, v234, v234
    v_dot2c_f32_bf16 v15, v233, v233
    v_dot2c_f32_bf16 v15, v232, v232
    v_dot2c_f32_bf16 v15, v231, v231
    v_dot2c_f32_bf16 v15, v230, v230
    v_dot2c_f32_bf16 v15, v229, v229
    v_dot2c_f32_bf16 v15, v228, v228
    v_dot2c_f32_bf16 v15, v227, v227
    v_dot2c_f32_bf16 v15, v226, v226
    v_dot2c_f32_bf16 v15, v225, v225
    v_dot2c_f32_bf16 v15, v224, v224
    s_waitcnt lgkmcnt(6)
    v_mfma_f32_32x32x16_bf16 v[64:79], v[224:227], a[72:75], v[64:79]
    s_add_u32 m0, s101, 90112
    ds_read_b64_tr_b16 a[88:89], v44 offset:16384
    buffer_load_dwordx4 v7, s[44:47], s25 offen offset:0  lds
    ds_read_b64_tr_b16 a[90:91], v44 offset:16896
    s_waitcnt lgkmcnt(6)
    v_mfma_f32_32x32x16_bf16 v[80:95], v[224:227], a[76:79], v[80:95]
    buffer_load_dwordx4 v8, s[44:47], s25 offen offset:1024  lds
    ds_read_b64_tr_b16 a[92:93], v45 offset:16384
    ds_read_b64_tr_b16 a[94:95], v45 offset:16896
    v_smfmac_f32_16x16x64_bf16 v[24:27], v[16:19], a[72:79], v28
    s_add_u32 m0, s100, 32768
    ds_read_b64_tr_b16 a[96:97], v46 offset:16384
    s_waitcnt lgkmcnt(7)
    v_mfma_f32_32x32x16_bf16 v[64:79], v[228:231], a[80:83], v[64:79]
    buffer_load_dwordx4 v3, s[40:43], s19 offen offset:0  lds
    ds_read_b64_tr_b16 a[98:99], v46 offset:16896
    ds_read_b64_tr_b16 a[100:101], v47 offset:16384
    s_waitcnt lgkmcnt(7)
    v_mfma_f32_32x32x16_bf16 v[80:95], v[228:231], a[84:87], v[80:95]
    buffer_load_dwordx4 v4, s[40:43], s19 offen offset:1024  lds
    ds_read_b64_tr_b16 a[102:103], v47 offset:16896
    s_waitcnt vmcnt(10)
    s_barrier
    v_smfmac_f32_16x16x64_bf16 v[20:23], v[16:19], v[224:231], v28
    ds_read_b128 v[240:243], v11 offset:0
    s_waitcnt lgkmcnt(7)
    v_mfma_f32_32x32x16_bf16 v[64:79], v[232:235], a[88:91], v[64:79]
    buffer_load_dwordx4 v5, s[40:43], s19 offen offset:2048  lds
    ds_read_b128 v[244:247], v12 offset:0
    ds_read_b128 v[248:251], v13 offset:0
    s_waitcnt lgkmcnt(7)
    v_mfma_f32_32x32x16_bf16 v[80:95], v[232:235], a[92:95], v[80:95]
    buffer_load_dwordx4 v6, s[40:43], s19 offen offset:3072  lds
    ds_read_b128 v[252:255], v14 offset:0
    ds_read_b64_tr_b16 a[72:73], v40 offset:24576
    v_smfmac_f32_16x16x64_bf16 v[20:23], v[16:19], v[232:239], v28
    ds_read_b64_tr_b16 a[74:75], v40 offset:25088
    s_waitcnt lgkmcnt(8)
    v_mfma_f32_32x32x16_bf16 v[64:79], v[236:239], a[96:99], v[64:79]
    ds_read_b64_tr_b16 a[76:77], v41 offset:24576
    ds_read_b64_tr_b16 a[78:79], v41 offset:25088
    ds_read_b64_tr_b16 a[80:81], v42 offset:24576
    ds_read_b64_tr_b16 a[82:83], v42 offset:25088
    s_waitcnt lgkmcnt(10)
    v_mfma_f32_32x32x16_bf16 v[80:95], v[236:239], a[100:103], v[80:95]
    ds_read_b64_tr_b16 a[84:85], v43 offset:24576
    ds_read_b64_tr_b16 a[86:87], v43 offset:25088
    s_waitcnt lgkmcnt(8)
    v_dot2c_f32_bf16 v15, v255, v255
    v_dot2c_f32_bf16 v15, v254, v254
    v_dot2c_f32_bf16 v15, v253, v253
    v_dot2c_f32_bf16 v15, v252, v252
    v_dot2c_f32_bf16 v15, v251, v251
    v_dot2c_f32_bf16 v15, v250, v250
    v_dot2c_f32_bf16 v15, v249, v249
    v_dot2c_f32_bf16 v15, v248, v248
    v_dot2c_f32_bf16 v15, v247, v247
    v_dot2c_f32_bf16 v15, v246, v246
    v_dot2c_f32_bf16 v15, v245, v245
    v_dot2c_f32_bf16 v15, v244, v244
    v_dot2c_f32_bf16 v15, v243, v243
    v_dot2c_f32_bf16 v15, v242, v242
    v_dot2c_f32_bf16 v15, v241, v241
    v_dot2c_f32_bf16 v15, v240, v240
    s_waitcnt lgkmcnt(6)
    v_mfma_f32_32x32x16_bf16 v[64:79], v[240:243], a[72:75], v[64:79]
    s_add_u32 m0, s101, 98304
    ds_read_b64_tr_b16 a[88:89], v44 offset:24576
    buffer_load_dwordx4 v7, s[44:47], s26 offen offset:0  lds
    ds_read_b64_tr_b16 a[90:91], v44 offset:25088
    s_waitcnt lgkmcnt(6)
    v_mfma_f32_32x32x16_bf16 v[80:95], v[240:243], a[76:79], v[80:95]
    buffer_load_dwordx4 v8, s[44:47], s26 offen offset:1024  lds
    ds_read_b64_tr_b16 a[92:93], v45 offset:24576
    ds_read_b64_tr_b16 a[94:95], v45 offset:25088
    v_smfmac_f32_16x16x64_bf16 v[24:27], v[16:19], a[72:79], v28
    s_add_u32 m0, s101, 106496
    ds_read_b64_tr_b16 a[96:97], v46 offset:24576
    s_waitcnt lgkmcnt(7)
    v_mfma_f32_32x32x16_bf16 v[64:79], v[244:247], a[80:83], v[64:79]
    buffer_load_dwordx4 v7, s[44:47], s27 offen offset:0  lds
    ds_read_b64_tr_b16 a[98:99], v46 offset:25088
    ds_read_b64_tr_b16 a[100:101], v47 offset:24576
    s_waitcnt lgkmcnt(7)
    v_mfma_f32_32x32x16_bf16 v[80:95], v[244:247], a[84:87], v[80:95]
    buffer_load_dwordx4 v8, s[44:47], s27 offen offset:1024  lds
    ds_read_b64_tr_b16 a[102:103], v47 offset:25088
    s_waitcnt vmcnt(8)
    s_barrier
    v_smfmac_f32_16x16x64_bf16 v[20:23], v[16:19], v[240:247], v28
    s_add_u32 m0, s100, 0
    ds_read_b128 v[128:131], v11 offset:16384
    s_waitcnt lgkmcnt(7)
    v_mfma_f32_32x32x16_bf16 v[64:79], v[248:251], a[88:91], v[64:79]
    buffer_load_dwordx4 v3, s[40:43], s20 offen offset:0  lds
    ds_read_b128 v[132:135], v12 offset:16384
    ds_read_b128 v[136:139], v13 offset:16384
    s_waitcnt lgkmcnt(7)
    v_mfma_f32_32x32x16_bf16 v[80:95], v[248:251], a[92:95], v[80:95]
    buffer_load_dwordx4 v4, s[40:43], s20 offen offset:1024  lds
    ds_read_b128 v[140:143], v14 offset:16384
    ds_read_b64_tr_b16 a[72:73], v40 offset:32768
    v_smfmac_f32_16x16x64_bf16 v[20:23], v[16:19], v[248:255], v28
    ds_read_b64_tr_b16 a[74:75], v40 offset:33280
    s_waitcnt lgkmcnt(8)
    v_mfma_f32_32x32x16_bf16 v[64:79], v[252:255], a[96:99], v[64:79]
    buffer_load_dwordx4 v5, s[40:43], s20 offen offset:2048  lds
    ds_read_b64_tr_b16 a[76:77], v41 offset:32768
    ds_read_b64_tr_b16 a[78:79], v41 offset:33280
    s_waitcnt lgkmcnt(8)
    v_mfma_f32_32x32x16_bf16 v[80:95], v[252:255], a[100:103], v[80:95]
    buffer_load_dwordx4 v6, s[40:43], s20 offen offset:3072  lds
    ds_read_b64_tr_b16 a[80:81], v42 offset:32768
    ds_read_b64_tr_b16 a[82:83], v42 offset:33280
    ds_read_b64_tr_b16 a[84:85], v43 offset:32768
    ds_read_b64_tr_b16 a[86:87], v43 offset:33280
    s_waitcnt lgkmcnt(8)
    v_dot2c_f32_bf16 v15, v143, v143
    v_dot2c_f32_bf16 v15, v142, v142
    v_dot2c_f32_bf16 v15, v141, v141
    v_dot2c_f32_bf16 v15, v140, v140
    v_dot2c_f32_bf16 v15, v139, v139
    v_dot2c_f32_bf16 v15, v138, v138
    v_dot2c_f32_bf16 v15, v137, v137
    v_dot2c_f32_bf16 v15, v136, v136
    v_dot2c_f32_bf16 v15, v135, v135
    v_dot2c_f32_bf16 v15, v134, v134
    v_dot2c_f32_bf16 v15, v133, v133
    v_dot2c_f32_bf16 v15, v132, v132
    v_dot2c_f32_bf16 v15, v131, v131
    v_dot2c_f32_bf16 v15, v130, v130
    v_dot2c_f32_bf16 v15, v129, v129
    v_dot2c_f32_bf16 v15, v128, v128
    s_waitcnt lgkmcnt(6)
    v_mfma_f32_32x32x16_bf16 v[64:79], v[128:131], a[72:75], v[64:79]
    s_add_u32 m0, s100, 16384
    ds_read_b64_tr_b16 a[88:89], v44 offset:32768
    buffer_load_dwordx4 v3, s[40:43], s21 offen offset:0  lds
    ds_read_b64_tr_b16 a[90:91], v44 offset:33280
    s_waitcnt lgkmcnt(6)
    v_mfma_f32_32x32x16_bf16 v[80:95], v[128:131], a[76:79], v[80:95]
    buffer_load_dwordx4 v4, s[40:43], s21 offen offset:1024  lds
    ds_read_b64_tr_b16 a[92:93], v45 offset:32768
    ds_read_b64_tr_b16 a[94:95], v45 offset:33280
    v_smfmac_f32_16x16x64_bf16 v[24:27], v[16:19], a[72:79], v28
    ds_read_b64_tr_b16 a[96:97], v46 offset:32768
    s_waitcnt lgkmcnt(7)
    v_mfma_f32_32x32x16_bf16 v[64:79], v[132:135], a[80:83], v[64:79]
    buffer_load_dwordx4 v5, s[40:43], s21 offen offset:2048  lds
    ds_read_b64_tr_b16 a[98:99], v46 offset:33280
    ds_read_b64_tr_b16 a[100:101], v47 offset:32768
    s_waitcnt lgkmcnt(7)
    v_mfma_f32_32x32x16_bf16 v[80:95], v[132:135], a[84:87], v[80:95]
    buffer_load_dwordx4 v6, s[40:43], s21 offen offset:3072  lds
    ds_read_b64_tr_b16 a[102:103], v47 offset:33280
    s_waitcnt vmcnt(12)
    v_smfmac_f32_16x16x64_bf16 v[20:23], v[16:19], v[128:135], v28
    s_add_u32 m0, s100, 115712
    ds_read_b128 v[144:147], v11 offset:32768
    s_waitcnt lgkmcnt(7)
    v_mfma_f32_32x32x16_bf16 v[64:79], v[136:139], a[88:91], v[64:79]
    buffer_load_dwordx4 v10, s[48:51], s35 offen offset:0 lds
    ds_read_b128 v[148:151], v12 offset:32768
    ds_read_b128 v[152:155], v13 offset:32768
    s_waitcnt lgkmcnt(7)
    v_mfma_f32_32x32x16_bf16 v[80:95], v[136:139], a[92:95], v[80:95]
    s_add_u32 m0, s100, 116672
    ds_read_b128 v[156:159], v14 offset:32768
    buffer_load_dwordx4 v10, s[48:51], s35 offen offset:64 lds
    ds_read_b64_tr_b16 a[72:73], v40 offset:40960
    v_smfmac_f32_16x16x64_bf16 v[20:23], v[16:19], v[136:143], v28
    s_add_u32 m0, s100, 117632
    ds_read_b64_tr_b16 a[74:75], v40 offset:41472
    s_waitcnt lgkmcnt(8)
    v_mfma_f32_32x32x16_bf16 v[64:79], v[140:143], a[96:99], v[64:79]
    buffer_load_dwordx4 v10, s[64:67], s35 offen offset:128 lds
    ds_read_b64_tr_b16 a[76:77], v41 offset:40960
    ds_read_b64_tr_b16 a[78:79], v41 offset:41472
    s_waitcnt lgkmcnt(8)
    v_mfma_f32_32x32x16_bf16 v[80:95], v[140:143], a[100:103], v[80:95]
    s_add_u32 m0, s100, 114688
    ds_read_b64_tr_b16 a[80:81], v42 offset:40960
    buffer_load_dwordx4 v9, s[44:47], s27 offen lds
    ds_read_b64_tr_b16 a[82:83], v42 offset:41472
    ds_read_b64_tr_b16 a[84:85], v43 offset:40960
    ds_read_b64_tr_b16 a[86:87], v43 offset:41472
    s_waitcnt lgkmcnt(8)
    v_dot2c_f32_bf16 v15, v159, v159
    v_dot2c_f32_bf16 v15, v158, v158
    v_dot2c_f32_bf16 v15, v157, v157
    v_dot2c_f32_bf16 v15, v156, v156
    v_dot2c_f32_bf16 v15, v155, v155
    v_dot2c_f32_bf16 v15, v154, v154
    v_dot2c_f32_bf16 v15, v153, v153
    v_dot2c_f32_bf16 v15, v152, v152
    v_dot2c_f32_bf16 v15, v151, v151
    v_dot2c_f32_bf16 v15, v150, v150
    v_dot2c_f32_bf16 v15, v149, v149
    v_dot2c_f32_bf16 v15, v148, v148
    v_dot2c_f32_bf16 v15, v147, v147
    v_dot2c_f32_bf16 v15, v146, v146
    v_dot2c_f32_bf16 v15, v145, v145
    v_dot2c_f32_bf16 v15, v144, v144
    s_waitcnt lgkmcnt(6)
    v_mfma_f32_32x32x16_bf16 v[64:79], v[144:147], a[72:75], v[64:79]
    buffer_load_ushort v29, v31, s[76:79], 0 offen offset:0
    ds_read_b64_tr_b16 a[88:89], v44 offset:40960
    ds_read_b64_tr_b16 a[90:91], v44 offset:41472
    s_waitcnt lgkmcnt(6)
    v_mfma_f32_32x32x16_bf16 v[80:95], v[144:147], a[76:79], v[80:95]
    buffer_load_ushort v30, v31, s[76:79], 0 offen offset:64
    ds_read_b64_tr_b16 a[92:93], v45 offset:40960
    ds_read_b64_tr_b16 a[94:95], v45 offset:41472
    v_smfmac_f32_16x16x64_bf16 v[24:27], v[16:19], a[72:79], v28
    ds_read_b64_tr_b16 a[96:97], v46 offset:40960
    s_waitcnt lgkmcnt(7)
    v_mfma_f32_32x32x16_bf16 v[64:79], v[148:151], a[80:83], v[64:79]
    buffer_load_ushort v31, v31, s[76:79], 0 offen offset:128
    ds_read_b64_tr_b16 a[98:99], v46 offset:41472
    ds_read_b64_tr_b16 a[100:101], v47 offset:40960
    s_waitcnt lgkmcnt(7)
    v_mfma_f32_32x32x16_bf16 v[80:95], v[148:151], a[84:87], v[80:95]
    global_load_dword a160, v1, s[80:81]
    ds_read_b64_tr_b16 a[102:103], v47 offset:41472
    s_waitcnt vmcnt(12)
    s_barrier
    s_lshl_b32 s10, s3, 8
    s_add_u32 s10, s10, s2
    s_sub_u32 s10, s10, 176
    s_cmp_ge_u32 s10, 16
    s_cbranch_scc1 L_nogo1
    v_mov_b32 v52, 1
    s_lshl_b32 s10, s10, 4
    s_mov_b64 exec, 1
    buffer_store_dword v52, v50, s[72:75], s10 offen sc1
    s_mov_b64 exec, -1
L_nogo1:
    v_smfmac_f32_16x16x64_bf16 v[20:23], v[16:19], v[144:151], v28
    ds_read_b128 v[160:163], v11 offset:0
    s_waitcnt lgkmcnt(7)
    v_mfma_f32_32x32x16_bf16 v[64:79], v[152:155], a[88:91], v[64:79]
    ds_read_b128 v[164:167], v12 offset:0
    ds_read_b128 v[168:171], v13 offset:0
    ds_read_b128 v[172:175], v14 offset:0
    ds_read_b64_tr_b16 a[72:73], v40 offset:49152
    s_waitcnt lgkmcnt(9)
    v_mfma_f32_32x32x16_bf16 v[80:95], v[152:155], a[92:95], v[80:95]
    ds_read_b64_tr_b16 a[74:75], v40 offset:49664
    ds_read_b64_tr_b16 a[76:77], v41 offset:49152
    ds_read_b64_tr_b16 a[78:79], v41 offset:49664
    ds_read_b64_tr_b16 a[80:81], v42 offset:49152
    v_smfmac_f32_16x16x64_bf16 v[20:23], v[16:19], v[152:159], v28
    ds_read_b64_tr_b16 a[82:83], v42 offset:49664
    s_waitcnt lgkmcnt(12)
    v_mfma_f32_32x32x16_bf16 v[64:79], v[156:159], a[96:99], v[64:79]
    ds_read_b64_tr_b16 a[84:85], v43 offset:49152
    ds_read_b64_tr_b16 a[86:87], v43 offset:49664
    s_waitcnt lgkmcnt(12)
    v_mfma_f32_32x32x16_bf16 v[80:95], v[156:159], a[100:103], v[80:95]
    s_waitcnt lgkmcnt(8)
    v_dot2c_f32_bf16 v15, v175, v175
    v_dot2c_f32_bf16 v15, v174, v174
    v_dot2c_f32_bf16 v15, v173, v173
    v_dot2c_f32_bf16 v15, v172, v172
    v_dot2c_f32_bf16 v15, v171, v171
    v_dot2c_f32_bf16 v15, v170, v170
    v_dot2c_f32_bf16 v15, v169, v169
    v_dot2c_f32_bf16 v15, v168, v168
    v_dot2c_f32_bf16 v15, v167, v167
    v_dot2c_f32_bf16 v15, v166, v166
    v_dot2c_f32_bf16 v15, v165, v165
    v_dot2c_f32_bf16 v15, v164, v164
    v_dot2c_f32_bf16 v15, v163, v163
    v_dot2c_f32_bf16 v15, v162, v162
    v_dot2c_f32_bf16 v15, v161, v161
    v_dot2c_f32_bf16 v15, v160, v160
    s_waitcnt lgkmcnt(6)
    v_mfma_f32_32x32x16_bf16 v[64:79], v[160:163], a[72:75], v[64:79]
    s_add_u32 m0, s100, 132096
    ds_read_b64_tr_b16 a[88:89], v44 offset:49152
    buffer_load_dwordx4 v10, s[48:51], s28 offen offset:0 lds
    ds_read_b64_tr_b16 a[90:91], v44 offset:49664
    s_waitcnt lgkmcnt(6)
    v_mfma_f32_32x32x16_bf16 v[80:95], v[160:163], a[76:79], v[80:95]
    s_add_u32 m0, s100, 133056
    ds_read_b64_tr_b16 a[92:93], v45 offset:49152
    buffer_load_dwordx4 v10, s[48:51], s28 offen offset:64 lds
    ds_read_b64_tr_b16 a[94:95], v45 offset:49664
    v_smfmac_f32_16x16x64_bf16 v[24:27], v[16:19], a[72:79], v28
    s_add_u32 m0, s100, 134016
    ds_read_b64_tr_b16 a[96:97], v46 offset:49152
    s_waitcnt lgkmcnt(7)
    v_mfma_f32_32x32x16_bf16 v[64:79], v[164:167], a[80:83], v[64:79]
    buffer_load_dwordx4 v10, s[64:67], s28 offen offset:128 lds
    ds_read_b64_tr_b16 a[98:99], v46 offset:49664
    ds_read_b64_tr_b16 a[100:101], v47 offset:49152
    s_waitcnt lgkmcnt(7)
    v_mfma_f32_32x32x16_bf16 v[80:95], v[164:167], a[84:87], v[80:95]
    ds_read_b64_tr_b16 a[102:103], v47 offset:49664
    s_waitcnt vmcnt(11)
    ds_read_b128 v[176:179], v11 offset:16384
    ds_read_b128 v[180:183], v12 offset:16384
    v_smfmac_f32_16x16x64_bf16 v[20:23], v[16:19], v[160:167], v28
    ds_read_b128 v[184:187], v13 offset:16384
    s_waitcnt lgkmcnt(9)
    v_mfma_f32_32x32x16_bf16 v[64:79], v[168:171], a[88:91], v[64:79]
    ds_read_b128 v[188:191], v14 offset:16384
    ds_read_b64_tr_b16 a[72:73], v40 offset:57344
    ds_read_b64_tr_b16 a[74:75], v40 offset:57856
    ds_read_b64_tr_b16 a[76:77], v41 offset:57344
    s_waitcnt lgkmcnt(11)
    v_mfma_f32_32x32x16_bf16 v[80:95], v[168:171], a[92:95], v[80:95]
    ds_read_b64_tr_b16 a[78:79], v41 offset:57856
    ds_read_b64_tr_b16 a[80:81], v42 offset:57344
    ds_read_b64_tr_b16 a[82:83], v42 offset:57856
    ds_read_b64_tr_b16 a[84:85], v43 offset:57344
    v_smfmac_f32_16x16x64_bf16 v[20:23], v[16:19], v[168:175], v28
    ds_read_b64_tr_b16 a[86:87], v43 offset:57856
    s_waitcnt lgkmcnt(14)
    v_mfma_f32_32x32x16_bf16 v[64:79], v[172:175], a[96:99], v[64:79]
    s_waitcnt lgkmcnt(12)
    v_mfma_f32_32x32x16_bf16 v[80:95], v[172:175], a[100:103], v[80:95]
    s_waitcnt lgkmcnt(8)
    v_dot2c_f32_bf16 v15, v191, v191
    v_dot2c_f32_bf16 v15, v190, v190
    v_dot2c_f32_bf16 v15, v189, v189
    v_dot2c_f32_bf16 v15, v188, v188
    v_dot2c_f32_bf16 v15, v187, v187
    v_dot2c_f32_bf16 v15, v186, v186
    v_dot2c_f32_bf16 v15, v185, v185
    v_dot2c_f32_bf16 v15, v184, v184
    v_dot2c_f32_bf16 v15, v183, v183
    v_dot2c_f32_bf16 v15, v182, v182
    v_dot2c_f32_bf16 v15, v181, v181
    v_dot2c_f32_bf16 v15, v180, v180
    v_dot2c_f32_bf16 v15, v179, v179
    v_dot2c_f32_bf16 v15, v178, v178
    v_dot2c_f32_bf16 v15, v177, v177
    v_dot2c_f32_bf16 v15, v176, v176
    s_waitcnt lgkmcnt(4)
    v_smfmac_f32_16x16x64_bf16 v[24:27], v[16:19], a[72:79], v28
    s_add_u32 m0, s100, 131072
    ds_read_b64_tr_b16 a[88:89], v44 offset:57344
    v_smfmac_f32_16x16x64_bf16 v[20:23], v[16:19], v[176:183], v28
    ds_read_b64_tr_b16 a[90:91], v44 offset:57856
    v_smfmac_f32_16x16x64_bf16 v[20:23], v[16:19], v[184:191], v28
    ds_read_b64_tr_b16 a[92:93], v45 offset:57344
    v_mfma_f32_32x32x16_bf16 v[64:79], v[176:179], a[72:75], v[64:79]
    buffer_load_dwordx4 v9, s[44:47], s38 offen lds
    ds_read_b64_tr_b16 a[94:95], v45 offset:57856
    ds_read_b64_tr_b16 a[96:97], v46 offset:57344
    ds_read_b64_tr_b16 a[98:99], v46 offset:57856
    ds_read_b64_tr_b16 a[100:101], v47 offset:57344
    v_mfma_f32_32x32x16_bf16 v[80:95], v[176:179], a[76:79], v[80:95]
    s_add_u32 m0, s100, 33792
    ds_read_b64_tr_b16 a[102:103], v47 offset:57856
    buffer_load_dwordx4 v10, s[48:51], s29 offen offset:0 lds
    v_add_f32 v24, v24, v25
    v_add_f32 v26, v26, v27
    ds_write_b32 v60, v24 offset:0
    s_waitcnt lgkmcnt(11)
    v_mfma_f32_32x32x16_bf16 v[64:79], v[180:183], a[80:83], v[64:79]
    s_add_u32 m0, s100, 34752
    ds_write_b32 v60, v26 offset:512
    buffer_load_dwordx4 v10, s[48:51], s29 offen offset:64 lds
    v_add_f32 v20, v20, v21
    v_add_f32 v22, v22, v23
    v_add_f32 v20, v20, v22
    s_waitcnt lgkmcnt(10)
    v_mfma_f32_32x32x16_bf16 v[80:95], v[180:183], a[84:87], v[80:95]
    s_add_u32 m0, s100, 35712
    v_mov_b32 v53, v15
    buffer_load_dwordx4 v10, s[64:67], s29 offen offset:128 lds
    s_nop 0
    v_permlane32_swap_b32 v15, v53
    v_add_f32 v15, v15, v53
    v_mul_f32 v15, 0x3b000000, v15
    s_waitcnt lgkmcnt(8)
    v_mfma_f32_32x32x16_bf16 v[64:79], v[184:187], a[88:91], v[64:79]
    s_add_u32 m0, s100, 32768
    v_mul_f32 v20, 0xbb000000, v20
    buffer_load_dwordx4 v9, s[44:47], s39 offen lds
    v_fma_f32 v21, -v20, v20, v15
    v_max_f32 v21, 0, v21
    v_add_f32 v21, 0x3727c5ac, v21
    s_waitcnt lgkmcnt(6)
    v_mfma_f32_32x32x16_bf16 v[80:95], v[184:187], a[92:95], v[80:95]
    v_rsq_f32 v22, v21
    s_waitcnt lgkmcnt(0)
    s_barrier
    ds_read_b128 v[96:99], v61 offset:0
    ds_read_b128 v[100:103], v61 offset:512
    v_mul_f32 v21, v21, v22
    v_cndmask_b32 v52, v20, v21, s[90:91]
    v_mfma_f32_32x32x16_bf16 v[64:79], v[188:191], a[96:99], v[64:79]
    v_and_b32 v53, 0xffff0000, v52
    v_sub_f32 v52, v52, v53
    v_cvt_pk_bf16_f32 v48, v53, v52
    v_cndmask_b32 v49, v48, 0, s[90:91]
    s_waitcnt lgkmcnt(1)
    v_add_f32 v96, v96, v98
    v_add_f32 v97, v97, v99
    v_mfma_f32_32x32x16_bf16 v[80:95], v[188:191], a[100:103], v[80:95]
    v_add_f32 v96, v96, v97
    v_and_b32 v97, 0xffff0000, v96
    v_sub_f32 v98, v96, v97
    v_cvt_pk_bf16_f32 v97, v97, v97
    v_cvt_pk_bf16_f32 v98, v98, v98
    v_cndmask_b32 v32, v97, 0, s[90:91]
    v_cndmask_b32 v33, v98, 0, s[90:91]
    s_waitcnt lgkmcnt(0)
    v_add_f32 v100, v100, v102
    v_add_f32 v101, v101, v103
    v_add_f32 v100, v100, v101
    v_and_b32 v101, 0xffff0000, v100
    v_sub_f32_e64 v102, v100, v101
    v_cvt_pk_bf16_f32 v101, v101, v101
    v_cvt_pk_bf16_f32 v102, v102, v102
    v_cndmask_b32 v36, v101, 0, s[90:91]
    v_cndmask_b32 v37, v102, 0, s[90:91]
    v_and_b32 v52, 0xffff0000, v22
    v_sub_f32 v53, v22, v52
    v_and_b32 v23, 0xffff0000, v53
    v_sub_f32 v53, v53, v23
    v_cvt_pk_bf16_f32 v52, v52, v23
    v_cvt_pk_bf16_f32 v53, v53, 0
    v_cndmask_b32 v52, v52, 0, s[90:91]
    v_cndmask_b32 v53, v53, 0, s[90:91]
    s_nop 1
    v_mfma_f32_32x32x16_bf16 v[96:111], v[52:55], v[56:59], 0
    v_mfma_f32_32x32x16_bf16 v[64:79], v[48:51], v[32:35], v[64:79]
    v_mfma_f32_32x32x16_bf16 v[80:95], v[48:51], v[36:39], v[80:95]
    v_mul_f32 v3, v22, v22
    v_lshlrev_b32 v11, 2, v0
    v_add_u32 v5, 262144, v62
    v_mov_b64 v[24:25], 0
    v_mov_b64 v[26:27], 0
    v_mov_b64 v[32:33], 0
    v_xor_b32_e64 v40, 0, v63
    v_xor_b32 v41, 4096, v63
    v_xor_b32 v42, 8192, v63
    v_xor_b32 v43, 12288, v63
    v_add_u32 v44, 81920, v40
    v_add_u32 v45, 81920, v41
    v_add_u32 v46, 81920, v42
    v_add_u32 v47, 81920, v43
    v_pk_mul_f32 v[64:65], v[64:65], v[96:97]
    v_pk_mul_f32 v[66:67], v[66:67], v[98:99]
    v_pk_mul_f32 v[68:69], v[68:69], v[100:101]
    v_pk_mul_f32 v[70:71], v[70:71], v[102:103]
    v_cvt_pk_bf16_f32 v52, v64, v65
    v_cvt_pk_bf16_f32 v53, v66, v67
    v_cvt_pk_bf16_f32 v54, v68, v69
    v_cvt_pk_bf16_f32 v55, v70, v71
    global_store_dwordx4 v62, v[52:55], s[60:61] offset:1024 sc1
    v_pk_mul_f32 v[72:73], v[72:73], v[104:105]
L_pad2:
    s_cbranch_execz L_pad6
    s_nop 0
    v_pk_mul_f32 v[74:75], v[74:75], v[106:107]
    v_pk_mul_f32 v[76:77], v[76:77], v[108:109]
    v_pk_mul_f32 v[78:79], v[78:79], v[110:111]
    v_cvt_pk_bf16_f32 v56, v72, v73
    v_cvt_pk_bf16_f32 v57, v74, v75
    v_cvt_pk_bf16_f32 v58, v76, v77
    v_cvt_pk_bf16_f32 v59, v78, v79
    global_store_dwordx4 v62, v[56:59], s[60:61] offset:1536 sc1
    v_pk_mul_f32 v[80:81], v[80:81], v[96:97]
    v_pk_mul_f32 v[82:83], v[82:83], v[98:99]
    v_pk_mul_f32 v[84:85], v[84:85], v[100:101]
    v_pk_mul_f32 v[86:87], v[86:87], v[102:103]
    v_cvt_pk_bf16_f32 v36, v80, v81
    v_cvt_pk_bf16_f32 v37, v82, v83
    v_cvt_pk_bf16_f32 v38, v84, v85
    v_cvt_pk_bf16_f32 v39, v86, v87
    global_store_dwordx4 v5, v[36:39], s[60:61] offset:1024 sc1
    v_pk_mul_f32 v[88:89], v[88:89], v[104:105]
    v_pk_mul_f32 v[90:91], v[90:91], v[106:107]
    v_pk_mul_f32 v[92:93], v[92:93], v[108:109]
    v_pk_mul_f32 v[94:95], v[94:95], v[110:111]
    v_cvt_pk_bf16_f32 v12, v88, v89
    v_cvt_pk_bf16_f32 v13, v90, v91
    v_cvt_pk_bf16_f32 v14, v92, v93
    v_cvt_pk_bf16_f32 v15, v94, v95
    global_store_dwordx4 v5, v[12:15], s[60:61] offset:1536 sc1
    buffer_store_dword v3, v11, s[60:63], s6 offen sc1
L_kvdone:
L_pad3:
    s_cbranch_execz L_pad7
    s_nop 0
    s_waitcnt vmcnt(5)
    s_barrier
    ds_read_b64_tr_b16 a[72:73], v44 offset:32768
    ds_read_b64_tr_b16 a[74:75], v44 offset:33024
    ds_read_b64_tr_b16 a[76:77], v44 offset:33792
    ds_read_b64_tr_b16 a[78:79], v44 offset:34048
    ds_read_b64_tr_b16 a[80:81], v44 offset:34816
    ds_read_b64_tr_b16 a[82:83], v44 offset:35072
    ds_read_b64_tr_b16 a[84:85], v44 offset:35840
    ds_read_b64_tr_b16 a[86:87], v44 offset:36096
    ds_read_b64_tr_b16 a[88:89], v45 offset:32768
    ds_read_b64_tr_b16 a[90:91], v45 offset:33024
    ds_read_b64_tr_b16 a[92:93], v45 offset:33792
    ds_read_b64_tr_b16 a[94:95], v45 offset:34048
    s_waitcnt lgkmcnt(8)
    v_mfma_f32_32x32x16_bf16 v[64:79], a[72:75], v[176:179], 0
    s_add_u32 m0, s100, 1024
    ds_read_b64_tr_b16 a[96:97], v45 offset:34816
    ds_read_b64_tr_b16 a[98:99], v45 offset:35072
    buffer_load_dwordx4 v10, s[48:51], s30 offen offset:0 lds
    v_and_b32 v8, 0xf0, v1
    buffer_load_dword v7, v8, s[72:75], s70 offen sc1
    v_mfma_f32_32x32x16_bf16 v[80:95], a[76:79], v[176:179], 0
    s_add_u32 m0, s100, 1984
    ds_read_b64_tr_b16 a[100:101], v45 offset:35840
    ds_read_b64_tr_b16 a[102:103], v45 offset:36096
    v_mul_f32 v20, 0x3eb8aa3b, v22
    v_mul_f32 v21, v21, v21
    v_accvgpr_read_b32 v22, a131
    v_smfmac_f32_16x16x64_bf16 v[24:27], v[16:19], a[72:79], v28
    ds_write_b32 v22, v21
    s_waitcnt lgkmcnt(9)
    v_mfma_f32_32x32x16_bf16 v[96:111], a[80:83], v[176:179], 0
    ds_read_b64_tr_b16 a[72:73], v46 offset:32768
    ds_read_b64_tr_b16 a[74:75], v46 offset:33024
    buffer_load_dwordx4 v10, s[48:51], s30 offen offset:64 lds
    v_mov_b32 v4, 1
    v_lshlrev_b32_e64 v5, 23, v0
    v_mfma_f32_32x32x16_bf16 v[112:127], a[84:87], v[176:179], 0
    s_add_u32 m0, s100, 2944
    ds_read_b64_tr_b16 a[76:77], v46 offset:33792
    ds_read_b64_tr_b16 a[78:79], v46 offset:34048
    v_accvgpr_read_b32 v22, a132
    v_accvgpr_read_b32 v3, a128
    v_accvgpr_read_b32 v6, a130
    v_smfmac_f32_16x16x64_bf16 v[32:35], v[16:19], a[80:87], v28
    v_accvgpr_read_b32 v62, a133
    s_waitcnt lgkmcnt(9)
    v_mfma_f32_32x32x16_bf16 v[64:79], a[88:91], v[180:183], v[64:79]
    ds_read_b64_tr_b16 a[80:81], v46 offset:34816
    ds_read_b64_tr_b16 a[82:83], v46 offset:35072
    buffer_load_dwordx4 v10, s[64:67], s30 offen offset:128 lds
    v_accvgpr_read_b32 v13, a134
    v_accvgpr_read_b32 v14, a135
    v_mfma_f32_32x32x16_bf16 v[80:95], a[92:95], v[180:183], v[80:95]
    s_add_u32 m0, s100, 0
    ds_read_b64_tr_b16 a[84:85], v46 offset:35840
    ds_read_b64_tr_b16 a[86:87], v46 offset:36096
    v_accvgpr_read_b32 v15, a140
    v_lshl_or_b32 v29, v29, 16, v29
    v_lshl_or_b32 v30, v30, 16, v30
    s_waitcnt lgkmcnt(9)
    v_mfma_f32_32x32x16_bf16 v[96:111], a[96:99], v[180:183], v[96:111]
    ds_read_b64_tr_b16 a[88:89], v47 offset:32768
    ds_read_b64_tr_b16 a[90:91], v47 offset:33024
    buffer_load_dwordx4 v9, s[44:47], s22 offen lds
    v_lshl_or_b32 v31, v31, 16, v31
    v_mfma_f32_32x32x16_bf16 v[112:127], a[100:103], v[180:183], v[112:127]
    ds_read_b64_tr_b16 a[92:93], v47 offset:33792
    ds_read_b64_tr_b16 a[94:95], v47 offset:34048
    s_waitcnt lgkmcnt(8)
    v_mfma_f32_32x32x16_bf16 v[64:79], a[72:75], v[184:187], v[64:79]
    ds_read_b64_tr_b16 a[96:97], v47 offset:34816
    ds_read_b64_tr_b16 a[98:99], v47 offset:35072
    v_mfma_f32_32x32x16_bf16 v[80:95], a[76:79], v[184:187], v[80:95]
    ds_read_b64_tr_b16 a[100:101], v47 offset:35840
    ds_read_b64_tr_b16 a[102:103], v47 offset:36096
    s_waitcnt lgkmcnt(8)
    v_mfma_f32_32x32x16_bf16 v[96:111], a[80:83], v[184:187], v[96:111]
    ds_read_b64_tr_b16 a[72:73], v44 offset:49152
    ds_read_b64_tr_b16 a[74:75], v44 offset:49408
    v_mfma_f32_32x32x16_bf16 v[112:127], a[84:87], v[184:187], v[112:127]
    ds_read_b64_tr_b16 a[76:77], v44 offset:50176
    ds_read_b64_tr_b16 a[78:79], v44 offset:50432
    s_waitcnt lgkmcnt(8)
    v_mfma_f32_32x32x16_bf16 v[64:79], a[88:91], v[188:191], v[64:79]
    ds_read_b64_tr_b16 a[80:81], v44 offset:51200
    ds_read_b64_tr_b16 a[82:83], v44 offset:51456
    v_mfma_f32_32x32x16_bf16 v[80:95], a[92:95], v[188:191], v[80:95]
    ds_read_b64_tr_b16 a[84:85], v44 offset:52224
    ds_read_b64_tr_b16 a[86:87], v44 offset:52480
    s_waitcnt lgkmcnt(8)
    v_mfma_f32_32x32x16_bf16 v[96:111], a[96:99], v[188:191], v[96:111]
    ds_read_b64_tr_b16 a[88:89], v45 offset:49152
    ds_read_b64_tr_b16 a[90:91], v45 offset:49408
    v_mfma_f32_32x32x16_bf16 v[112:127], a[100:103], v[188:191], v[112:127]
    ds_read_b64_tr_b16 a[92:93], v45 offset:50176
    ds_read_b64_tr_b16 a[94:95], v45 offset:50432
    s_waitcnt lgkmcnt(8)
    v_mfma_f32_32x32x16_bf16 v[64:79], a[72:75], v[192:195], v[64:79]
    s_add_u32 m0, s100, 17408
    ds_read_b64_tr_b16 a[96:97], v45 offset:51200
    ds_read_b64_tr_b16 a[98:99], v45 offset:51456
    buffer_load_dwordx4 v10, s[48:51], s31 offen offset:0 lds
    v_mfma_f32_32x32x16_bf16 v[80:95], a[76:79], v[192:195], v[80:95]
    s_add_u32 m0, s100, 18368
    ds_read_b64_tr_b16 a[100:101], v45 offset:52224
    ds_read_b64_tr_b16 a[102:103], v45 offset:52480
    v_smfmac_f32_16x16x64_bf16 v[24:27], v[16:19], a[72:79], v28
    s_waitcnt lgkmcnt(8)
    v_mfma_f32_32x32x16_bf16 v[96:111], a[80:83], v[192:195], v[96:111]
    ds_read_b64_tr_b16 a[72:73], v46 offset:49152
    ds_read_b64_tr_b16 a[74:75], v46 offset:49408
    buffer_load_dwordx4 v10, s[48:51], s31 offen offset:64 lds
    v_mfma_f32_32x32x16_bf16 v[112:127], a[84:87], v[192:195], v[112:127]
    s_add_u32 m0, s100, 19328
    ds_read_b64_tr_b16 a[76:77], v46 offset:50176
    ds_read_b64_tr_b16 a[78:79], v46 offset:50432
    v_smfmac_f32_16x16x64_bf16 v[32:35], v[16:19], a[80:87], v28
    s_waitcnt lgkmcnt(8)
    v_mfma_f32_32x32x16_bf16 v[64:79], a[88:91], v[196:199], v[64:79]
    ds_read_b64_tr_b16 a[80:81], v46 offset:51200
    ds_read_b64_tr_b16 a[82:83], v46 offset:51456
    buffer_load_dwordx4 v10, s[64:67], s31 offen offset:128 lds
    v_mfma_f32_32x32x16_bf16 v[80:95], a[92:95], v[196:199], v[80:95]
    s_add_u32 m0, s100, 16384
    ds_read_b64_tr_b16 a[84:85], v46 offset:52224
    ds_read_b64_tr_b16 a[86:87], v46 offset:52480
    s_waitcnt lgkmcnt(8)
    v_mfma_f32_32x32x16_bf16 v[96:111], a[96:99], v[196:199], v[96:111]
    ds_read_b64_tr_b16 a[88:89], v47 offset:49152
    ds_read_b64_tr_b16 a[90:91], v47 offset:49408
    buffer_load_dwordx4 v9, s[44:47], s23 offen lds
    v_mfma_f32_32x32x16_bf16 v[112:127], a[100:103], v[196:199], v[112:127]
    ds_read_b64_tr_b16 a[92:93], v47 offset:50176
    ds_read_b64_tr_b16 a[94:95], v47 offset:50432
    s_waitcnt lgkmcnt(8)
    v_mfma_f32_32x32x16_bf16 v[64:79], a[72:75], v[200:203], v[64:79]
    ds_read_b64_tr_b16 a[96:97], v47 offset:51200
    ds_read_b64_tr_b16 a[98:99], v47 offset:51456
    v_mfma_f32_32x32x16_bf16 v[80:95], a[76:79], v[200:203], v[80:95]
    ds_read_b64_tr_b16 a[100:101], v47 offset:52224
    ds_read_b64_tr_b16 a[102:103], v47 offset:52480
    s_waitcnt lgkmcnt(8)
    v_mfma_f32_32x32x16_bf16 v[96:111], a[80:83], v[200:203], v[96:111]
    ds_read_b64_tr_b16 a[72:73], v40 offset:32768
    ds_read_b64_tr_b16 a[74:75], v40 offset:33024
    v_mfma_f32_32x32x16_bf16 v[112:127], a[84:87], v[200:203], v[112:127]
    ds_read_b64_tr_b16 a[76:77], v40 offset:33792
    ds_read_b64_tr_b16 a[78:79], v40 offset:34048
    s_waitcnt lgkmcnt(8)
    v_mfma_f32_32x32x16_bf16 v[64:79], a[88:91], v[204:207], v[64:79]
    ds_read_b64_tr_b16 a[80:81], v40 offset:34816
    ds_read_b64_tr_b16 a[82:83], v40 offset:35072
    v_mfma_f32_32x32x16_bf16 v[80:95], a[92:95], v[204:207], v[80:95]
    ds_read_b64_tr_b16 a[84:85], v40 offset:35840
    ds_read_b64_tr_b16 a[86:87], v40 offset:36096
    s_waitcnt lgkmcnt(8)
    v_mfma_f32_32x32x16_bf16 v[96:111], a[96:99], v[204:207], v[96:111]
    ds_read_b64_tr_b16 a[88:89], v41 offset:32768
    ds_read_b64_tr_b16 a[90:91], v41 offset:33024
    v_mfma_f32_32x32x16_bf16 v[112:127], a[100:103], v[204:207], v[112:127]
    ds_read_b64_tr_b16 a[92:93], v41 offset:33792
    ds_read_b64_tr_b16 a[94:95], v41 offset:34048
    s_waitcnt lgkmcnt(8)
    v_mfma_f32_32x32x16_bf16 v[64:79], a[72:75], v[208:211], v[64:79]
    s_add_u32 m0, s100, 50176
    ds_read_b64_tr_b16 a[96:97], v41 offset:34816
    ds_read_b64_tr_b16 a[98:99], v41 offset:35072
    buffer_load_dwordx4 v10, s[48:51], s32 offen offset:0 lds
    v_mfma_f32_32x32x16_bf16 v[80:95], a[76:79], v[208:211], v[80:95]
    s_add_u32 m0, s100, 51136
    ds_read_b64_tr_b16 a[100:101], v41 offset:35840
    ds_read_b64_tr_b16 a[102:103], v41 offset:36096
    v_smfmac_f32_16x16x64_bf16 v[24:27], v[16:19], a[72:79], v28
    s_waitcnt lgkmcnt(8)
    v_mfma_f32_32x32x16_bf16 v[96:111], a[80:83], v[208:211], v[96:111]
    ds_read_b64_tr_b16 a[72:73], v42 offset:32768
    ds_read_b64_tr_b16 a[74:75], v42 offset:33024
    buffer_load_dwordx4 v10, s[48:51], s32 offen offset:64 lds
    v_mfma_f32_32x32x16_bf16 v[112:127], a[84:87], v[208:211], v[112:127]
    s_add_u32 m0, s100, 52096
    ds_read_b64_tr_b16 a[76:77], v42 offset:33792
    ds_read_b64_tr_b16 a[78:79], v42 offset:34048
    v_smfmac_f32_16x16x64_bf16 v[32:35], v[16:19], a[80:87], v28
    s_waitcnt lgkmcnt(8)
    v_mfma_f32_32x32x16_bf16 v[64:79], a[88:91], v[212:215], v[64:79]
    ds_read_b64_tr_b16 a[80:81], v42 offset:34816
    ds_read_b64_tr_b16 a[82:83], v42 offset:35072
    buffer_load_dwordx4 v10, s[64:67], s32 offen offset:128 lds
    v_mfma_f32_32x32x16_bf16 v[80:95], a[92:95], v[212:215], v[80:95]
    s_add_u32 m0, s100, 49152
    ds_read_b64_tr_b16 a[84:85], v42 offset:35840
    ds_read_b64_tr_b16 a[86:87], v42 offset:36096
    s_waitcnt lgkmcnt(8)
    v_mfma_f32_32x32x16_bf16 v[96:111], a[96:99], v[212:215], v[96:111]
    ds_read_b64_tr_b16 a[88:89], v43 offset:32768
    ds_read_b64_tr_b16 a[90:91], v43 offset:33024
    buffer_load_dwordx4 v9, s[44:47], s24 offen lds
    v_mfma_f32_32x32x16_bf16 v[112:127], a[100:103], v[212:215], v[112:127]
    ds_read_b64_tr_b16 a[92:93], v43 offset:33792
    ds_read_b64_tr_b16 a[94:95], v43 offset:34048
    s_waitcnt lgkmcnt(8)
    v_mfma_f32_32x32x16_bf16 v[64:79], a[72:75], v[216:219], v[64:79]
    ds_read_b64_tr_b16 a[96:97], v43 offset:34816
    ds_read_b64_tr_b16 a[98:99], v43 offset:35072
    v_mfma_f32_32x32x16_bf16 v[80:95], a[76:79], v[216:219], v[80:95]
    ds_read_b64_tr_b16 a[100:101], v43 offset:35840
    ds_read_b64_tr_b16 a[102:103], v43 offset:36096
    s_waitcnt lgkmcnt(8)
    v_mfma_f32_32x32x16_bf16 v[96:111], a[80:83], v[216:219], v[96:111]
    s_waitcnt vmcnt(4)
    v_cmp_ne_u32 vcc, s71, v7
    s_cbranch_vccnz L_go_retry
L_go_ok:
    s_barrier
    buffer_store_dword v4, v5, s[60:63], s12 offen sc1
    ds_read_b64_tr_b16 a[72:73], v40 offset:0
    ds_read_b64_tr_b16 a[74:75], v40 offset:256
    v_mfma_f32_32x32x16_bf16 v[112:127], a[84:87], v[216:219], v[112:127]
    ds_read_b64_tr_b16 a[76:77], v40 offset:1024
    ds_read_b64_tr_b16 a[78:79], v40 offset:1280
    s_waitcnt lgkmcnt(8)
    v_mfma_f32_32x32x16_bf16 v[64:79], a[88:91], v[220:223], v[64:79]
    s_add_u32 m0, s100, 82944
    ds_read_b64_tr_b16 a[80:81], v40 offset:2048
    ds_read_b64_tr_b16 a[82:83], v40 offset:2304
    buffer_load_dwordx4 v10, s[48:51], s33 offen offset:0 lds
    v_mfma_f32_32x32x16_bf16 v[80:95], a[92:95], v[220:223], v[80:95]
    s_add_u32 m0, s100, 83904
    ds_read_b64_tr_b16 a[84:85], v40 offset:3072
    ds_read_b64_tr_b16 a[86:87], v40 offset:3328
    s_waitcnt lgkmcnt(8)
    v_mfma_f32_32x32x16_bf16 v[96:111], a[96:99], v[220:223], v[96:111]
    ds_read_b64_tr_b16 a[88:89], v41 offset:0
    ds_read_b64_tr_b16 a[90:91], v41 offset:256
    buffer_load_dwordx4 v10, s[48:51], s33 offen offset:64 lds
    v_mfma_f32_32x32x16_bf16 v[112:127], a[100:103], v[220:223], v[112:127]
    s_add_u32 m0, s100, 84864
    ds_read_b64_tr_b16 a[92:93], v41 offset:1024
    ds_read_b64_tr_b16 a[94:95], v41 offset:1280
    s_waitcnt lgkmcnt(8)
    v_mfma_f32_32x32x16_bf16 v[64:79], a[72:75], v[224:227], v[64:79]
    ds_read_b64_tr_b16 a[96:97], v41 offset:2048
    ds_read_b64_tr_b16 a[98:99], v41 offset:2304
    buffer_load_dwordx4 v10, s[64:67], s33 offen offset:128 lds
    v_mfma_f32_32x32x16_bf16 v[80:95], a[76:79], v[224:227], v[80:95]
    s_add_u32 m0, s100, 81920
    ds_read_b64_tr_b16 a[100:101], v41 offset:3072
    ds_read_b64_tr_b16 a[102:103], v41 offset:3328
    v_smfmac_f32_16x16x64_bf16 v[24:27], v[16:19], a[72:79], v28
    s_waitcnt lgkmcnt(8)
    v_mfma_f32_32x32x16_bf16 v[96:111], a[80:83], v[224:227], v[96:111]
    ds_read_b64_tr_b16 a[72:73], v42 offset:0
    ds_read_b64_tr_b16 a[74:75], v42 offset:256
    buffer_load_dwordx4 v9, s[44:47], s25 offen lds
    v_mfma_f32_32x32x16_bf16 v[112:127], a[84:87], v[224:227], v[112:127]
    ds_read_b64_tr_b16 a[76:77], v42 offset:1024
    ds_read_b64_tr_b16 a[78:79], v42 offset:1280
    v_smfmac_f32_16x16x64_bf16 v[32:35], v[16:19], a[80:87], v28
    s_waitcnt lgkmcnt(8)
    v_mfma_f32_32x32x16_bf16 v[64:79], a[88:91], v[228:231], v[64:79]
    ds_read_b64_tr_b16 a[80:81], v42 offset:2048
    ds_read_b64_tr_b16 a[82:83], v42 offset:2304
    v_mfma_f32_32x32x16_bf16 v[80:95], a[92:95], v[228:231], v[80:95]
    ds_read_b64_tr_b16 a[84:85], v42 offset:3072
    ds_read_b64_tr_b16 a[86:87], v42 offset:3328
    s_waitcnt lgkmcnt(8)
    v_mfma_f32_32x32x16_bf16 v[96:111], a[96:99], v[228:231], v[96:111]
    ds_read_b64_tr_b16 a[88:89], v43 offset:0
    ds_read_b64_tr_b16 a[90:91], v43 offset:256
    v_mfma_f32_32x32x16_bf16 v[112:127], a[100:103], v[228:231], v[112:127]
    ds_read_b64_tr_b16 a[92:93], v43 offset:1024
    ds_read_b64_tr_b16 a[94:95], v43 offset:1280
    s_waitcnt lgkmcnt(8)
    v_mfma_f32_32x32x16_bf16 v[64:79], a[72:75], v[232:235], v[64:79]
    s_add_u32 m0, s100, 99328
    ds_read_b64_tr_b16 a[96:97], v43 offset:2048
    ds_read_b64_tr_b16 a[98:99], v43 offset:2304
    buffer_load_dwordx4 v10, s[48:51], s34 offen offset:0 lds
    v_mfma_f32_32x32x16_bf16 v[80:95], a[76:79], v[232:235], v[80:95]
    s_add_u32 m0, s100, 100288
    ds_read_b64_tr_b16 a[100:101], v43 offset:3072
    ds_read_b64_tr_b16 a[102:103], v43 offset:3328
    s_waitcnt lgkmcnt(8)
    v_mfma_f32_32x32x16_bf16 v[96:111], a[80:83], v[232:235], v[96:111]
    ds_read_b64_tr_b16 a[72:73], v40 offset:16384
    ds_read_b64_tr_b16 a[74:75], v40 offset:16640
    buffer_load_dwordx4 v10, s[48:51], s34 offen offset:64 lds
    v_mfma_f32_32x32x16_bf16 v[112:127], a[84:87], v[232:235], v[112:127]
    s_add_u32 m0, s100, 101248
    ds_read_b64_tr_b16 a[76:77], v40 offset:17408
    ds_read_b64_tr_b16 a[78:79], v40 offset:17664
    s_waitcnt lgkmcnt(8)
    v_mfma_f32_32x32x16_bf16 v[64:79], a[88:91], v[236:239], v[64:79]
    ds_read_b64_tr_b16 a[80:81], v40 offset:18432
    ds_read_b64_tr_b16 a[82:83], v40 offset:18688
    buffer_load_dwordx4 v10, s[64:67], s34 offen offset:128 lds
    v_mfma_f32_32x32x16_bf16 v[80:95], a[92:95], v[236:239], v[80:95]
    s_add_u32 m0, s100, 98304
    ds_read_b64_tr_b16 a[84:85], v40 offset:19456
    ds_read_b64_tr_b16 a[86:87], v40 offset:19712
    s_waitcnt lgkmcnt(8)
    v_mfma_f32_32x32x16_bf16 v[96:111], a[96:99], v[236:239], v[96:111]
    ds_read_b64_tr_b16 a[88:89], v41 offset:16384
    ds_read_b64_tr_b16 a[90:91], v41 offset:16640
    buffer_load_dwordx4 v9, s[44:47], s26 offen lds
    v_mfma_f32_32x32x16_bf16 v[112:127], a[100:103], v[236:239], v[112:127]
    ds_read_b64_tr_b16 a[92:93], v41 offset:17408
    ds_read_b64_tr_b16 a[94:95], v41 offset:17664
    s_waitcnt lgkmcnt(8)
    v_mfma_f32_32x32x16_bf16 v[64:79], a[72:75], v[240:243], v[64:79]
    ds_read_b64_tr_b16 a[96:97], v41 offset:18432
    ds_read_b64_tr_b16 a[98:99], v41 offset:18688
    v_mfma_f32_32x32x16_bf16 v[80:95], a[76:79], v[240:243], v[80:95]
    ds_read_b64_tr_b16 a[100:101], v41 offset:19456
    ds_read_b64_tr_b16 a[102:103], v41 offset:19712
    v_smfmac_f32_16x16x64_bf16 v[24:27], v[16:19], a[72:79], v28
    s_waitcnt lgkmcnt(8)
    v_mfma_f32_32x32x16_bf16 v[96:111], a[80:83], v[240:243], v[96:111]
    ds_read_b64_tr_b16 a[72:73], v42 offset:16384
    ds_read_b64_tr_b16 a[74:75], v42 offset:16640
    v_mfma_f32_32x32x16_bf16 v[112:127], a[84:87], v[240:243], v[112:127]
    ds_read_b64_tr_b16 a[76:77], v42 offset:17408
    ds_read_b64_tr_b16 a[78:79], v42 offset:17664
    v_smfmac_f32_16x16x64_bf16 v[32:35], v[16:19], a[80:87], v28
    s_waitcnt lgkmcnt(8)
    v_mfma_f32_32x32x16_bf16 v[64:79], a[88:91], v[244:247], v[64:79]
    ds_read_b64_tr_b16 a[80:81], v42 offset:18432
    ds_read_b64_tr_b16 a[82:83], v42 offset:18688
    v_accvgpr_read_b32 v5, a136
    v_accvgpr_read_b32 v7, a137
    v_accvgpr_read_b32 v9, a138
    v_accvgpr_read_b32 v10, a139
    v_mfma_f32_32x32x16_bf16 v[80:95], a[92:95], v[244:247], v[80:95]
    ds_read_b64_tr_b16 a[84:85], v42 offset:19456
    ds_read_b64_tr_b16 a[86:87], v42 offset:19712
    v_mov_b32 v4, 0xdddddddd
    v_mov_b64 v[216:217], -1
    v_mov_b64 v[218:219], -1
    s_waitcnt lgkmcnt(8)
    v_mfma_f32_32x32x16_bf16 v[96:111], a[96:99], v[244:247], v[96:111]
    s_waitcnt vmcnt(4)
    s_barrier
    ds_read_b64_tr_b16 a[88:89], v40 offset:49152
    ds_read_b64_tr_b16 a[90:91], v40 offset:49408
    s_add_u32 s64, s60, 8388608
    s_addc_u32 s65, s61, 0
    v_mfma_f32_32x32x16_bf16 v[112:127], a[100:103], v[244:247], v[112:127]
    ds_read_b64_tr_b16 a[92:93], v40 offset:50176
    ds_read_b64_tr_b16 a[94:95], v40 offset:50432
    s_waitcnt lgkmcnt(8)
    v_mfma_f32_32x32x16_bf16 v[64:79], a[72:75], v[248:251], v[64:79]
    ds_read_b64_tr_b16 a[96:97], v40 offset:51200
    ds_read_b64_tr_b16 a[98:99], v40 offset:51456
    v_mfma_f32_32x32x16_bf16 v[80:95], a[76:79], v[248:251], v[80:95]
    ds_read_b64_tr_b16 a[100:101], v40 offset:52224
    ds_read_b64_tr_b16 a[102:103], v40 offset:52480
    s_waitcnt lgkmcnt(8)
    v_mfma_f32_32x32x16_bf16 v[96:111], a[80:83], v[248:251], v[96:111]
    ds_read_b64_tr_b16 a[72:73], v44 offset:0
    ds_read_b64_tr_b16 a[74:75], v44 offset:256
    v_mfma_f32_32x32x16_bf16 v[112:127], a[84:87], v[248:251], v[112:127]
    ds_read_b64_tr_b16 a[76:77], v44 offset:1024
    ds_read_b64_tr_b16 a[78:79], v44 offset:1280
    s_waitcnt lgkmcnt(8)
    v_mfma_f32_32x32x16_bf16 v[64:79], a[88:91], v[128:131], v[64:79]
    ds_read_b64_tr_b16 a[80:81], v44 offset:2048
    ds_read_b64_tr_b16 a[82:83], v44 offset:2304
    v_accvgpr_read_b32 v248, a129
    v_mov_b32 v249, 1
    v_accvgpr_read_b32 v250, a142
    v_accvgpr_read_b32 v251, a143
    v_mfma_f32_32x32x16_bf16 v[80:95], a[92:95], v[128:131], v[80:95]
    ds_read_b64_tr_b16 a[84:85], v44 offset:3072
    ds_read_b64_tr_b16 a[86:87], v44 offset:3328
    v_mov_b32 v237, 0x3f803f80
    v_cndmask_b32 v238, v237, 0, s[90:91]
    v_cndmask_b32 v242, 0, v237, s[90:91]
    v_smfmac_f32_16x16x64_bf16 v[24:27], v[16:19], a[88:95], v28
    v_mov_b32 v239, 0
    s_waitcnt lgkmcnt(8)
    v_mfma_f32_32x32x16_bf16 v[96:111], a[96:99], v[128:131], v[96:111]
    s_waitcnt vmcnt(0)
    s_barrier
    ds_read_b64_tr_b16 a[88:89], v44 offset:16384
    ds_read_b64_tr_b16 a[90:91], v44 offset:16640
    v_mov_b64 v[240:241], 0
    v_mov_b32 v243, 0
    v_mov_b64 v[244:245], 0
    v_mfma_f32_32x32x16_bf16 v[112:127], a[100:103], v[128:131], v[112:127]
    ds_read_b64_tr_b16 a[92:93], v44 offset:17408
    ds_read_b64_tr_b16 a[94:95], v44 offset:17664
    v_smfmac_f32_16x16x64_bf16 v[32:35], v[16:19], a[96:103], v28
    s_waitcnt lgkmcnt(8)
    v_mfma_f32_32x32x16_bf16 v[64:79], a[72:75], v[144:147], v[64:79]
    ds_read_b64_tr_b16 a[96:97], v44 offset:18432
    ds_read_b64_tr_b16 a[98:99], v44 offset:18688
    v_mfma_f32_32x32x16_bf16 v[80:95], a[76:79], v[144:147], v[80:95]
    ds_read_b64_tr_b16 a[100:101], v44 offset:19456
    ds_read_b64_tr_b16 a[102:103], v44 offset:19712
    v_smfmac_f32_16x16x64_bf16 v[24:27], v[16:19], a[72:79], v28
    s_waitcnt lgkmcnt(8)
    v_mfma_f32_32x32x16_bf16 v[96:111], a[80:83], v[144:147], v[96:111]
    ds_read_b64_tr_b16 a[72:73], v43 offset:16384
    ds_read_b64_tr_b16 a[74:75], v43 offset:16640
    v_mfma_f32_32x32x16_bf16 v[112:127], a[84:87], v[144:147], v[112:127]
    ds_read_b64_tr_b16 a[76:77], v43 offset:17408
    ds_read_b64_tr_b16 a[78:79], v43 offset:17664
    v_smfmac_f32_16x16x64_bf16 v[32:35], v[16:19], a[80:87], v28
    s_waitcnt lgkmcnt(8)
    v_mfma_f32_32x32x16_bf16 v[64:79], a[88:91], v[160:163], v[64:79]
    ds_read_b64_tr_b16 a[80:81], v43 offset:18432
    ds_read_b64_tr_b16 a[82:83], v43 offset:18688
    v_mfma_f32_32x32x16_bf16 v[80:95], a[92:95], v[160:163], v[80:95]
    ds_read_b64_tr_b16 a[84:85], v43 offset:19456
    ds_read_b64_tr_b16 a[86:87], v43 offset:19712
    v_smfmac_f32_16x16x64_bf16 v[24:27], v[16:19], a[88:95], v28
    s_waitcnt lgkmcnt(8)
    v_mfma_f32_32x32x16_bf16 v[96:111], a[96:99], v[160:163], v[96:111]
    ds_read_b64_tr_b16 a[88:89], v41 offset:49152
    ds_read_b64_tr_b16 a[90:91], v41 offset:49408
    v_mfma_f32_32x32x16_bf16 v[112:127], a[100:103], v[160:163], v[112:127]
    ds_read_b64_tr_b16 a[92:93], v42 offset:49152
    ds_read_b64_tr_b16 a[94:95], v42 offset:49408
    s_nop 0
    v_add_f32 v24, v24, v25
    ds_write_b32 v60, v24 offset:1024
    v_add_f32_e64 v26, v26, v27
    v_smfmac_f32_16x16x64_bf16 v[32:35], v[16:19], a[96:103], v28
    ds_write_b32 v60, v26 offset:1536
    s_waitcnt lgkmcnt(10)
    v_mfma_f32_32x32x16_bf16 v[64:79], a[72:75], v[252:255], v[64:79]
    ds_read_b64_tr_b16 a[96:97], v43 offset:49152
    ds_read_b64_tr_b16 a[98:99], v43 offset:49408
    v_mfma_f32_32x32x16_bf16 v[80:95], a[76:79], v[252:255], v[80:95]
    ds_read_b64_tr_b16 a[100:101], v45 offset:0
    ds_read_b64_tr_b16 a[102:103], v45 offset:256
    v_add_f32 v32, v32, v33
    ds_write_b32 v60, v32 offset:2048
    v_add_f32_e64 v34, v34, v35
    s_waitcnt lgkmcnt(11)
    v_mfma_f32_32x32x16_bf16 v[96:111], a[80:83], v[252:255], v[96:111]
    ds_read_b64_tr_b16 a[72:73], v46 offset:0
    ds_read_b64_tr_b16 a[74:75], v46 offset:256
    ds_write_b32 v60, v34 offset:2560
    buffer_load_dword v8, v6, s[60:63], s13 offen sc1
    v_mfma_f32_32x32x16_bf16 v[112:127], a[84:87], v[252:255], v[112:127]
    ds_read_b64_tr_b16 a[76:77], v47 offset:0
    ds_read_b64_tr_b16 a[78:79], v47 offset:256
    s_waitcnt lgkmcnt(2)
    s_barrier
    ds_read_b128 v[200:203], v61 offset:1024
    ds_read_b128 v[204:207], v61 offset:1536
    v_mfma_f32_32x32x16_bf16 v[64:79], a[88:91], v[132:135], v[64:79]
    ds_read_b64_tr_b16 a[80:81], v45 offset:16384
    ds_read_b64_tr_b16 a[82:83], v45 offset:16640
    ds_read_b128 v[208:211], v61 offset:2048
    ds_read_b128 v[212:215], v61 offset:2560
    v_mfma_f32_32x32x16_bf16 v[64:79], a[92:95], v[136:139], v[64:79]
    ds_read_b64_tr_b16 a[84:85], v46 offset:16384
    ds_read_b64_tr_b16 a[86:87], v46 offset:16640
    v_mfma_f32_32x32x16_bf16 v[64:79], a[96:99], v[140:143], v[64:79]
    ds_read_b64_tr_b16 a[88:89], v47 offset:16384
    ds_read_b64_tr_b16 a[90:91], v47 offset:16640
    s_waitcnt lgkmcnt(9)
    v_add_f32 v200, v200, v202
    v_add_f32 v201, v201, v203
    v_add_f32 v200, v200, v201
    v_and_b32 v201, 0xffff0000, v200
    v_mfma_f32_32x32x16_bf16 v[64:79], a[100:103], v[148:151], v[64:79]
    ds_read_b64_tr_b16 a[92:93], v41 offset:50176
    ds_read_b64_tr_b16 a[94:95], v41 offset:50432
    v_sub_f32_e64 v202, v200, v201
    v_cvt_pk_bf16_f32 v201, v201, v201
    v_cvt_pk_bf16_f32 v202, v202, v202
    v_mfma_f32_32x32x16_bf16 v[64:79], a[72:75], v[152:155], v[64:79]
    ds_read_b64_tr_b16 a[96:97], v42 offset:50176
    ds_read_b64_tr_b16 a[98:99], v42 offset:50432
    v_cndmask_b32 v220, v201, 0, s[90:91]
    v_cndmask_b32 v221, v202, 0, s[90:91]
    v_mov_b64 v[222:223], 0
    s_waitcnt lgkmcnt(12)
    v_add_f32 v204, v204, v206
    v_mfma_f32_32x32x16_bf16 v[64:79], a[76:79], v[156:159], v[64:79]
    ds_read_b64_tr_b16 a[100:101], v43 offset:50176
    ds_read_b64_tr_b16 a[102:103], v43 offset:50432
    v_add_f32 v205, v205, v207
    v_add_f32 v204, v204, v205
    v_and_b32 v205, 0xffff0000, v204
    s_waitcnt lgkmcnt(8)
    v_mfma_f32_32x32x16_bf16 v[64:79], a[80:83], v[164:167], v[64:79]
    ds_read_b64_tr_b16 a[72:73], v45 offset:1024
    ds_read_b64_tr_b16 a[74:75], v45 offset:1280
    v_sub_f32_e64 v206, v204, v205
    v_cvt_pk_bf16_f32 v205, v205, v205
    v_cvt_pk_bf16_f32 v206, v206, v206
    v_cndmask_b32 v224, v205, v29, s[90:91]
    v_mfma_f32_32x32x16_bf16 v[64:79], a[84:87], v[168:171], v[64:79]
    ds_read_b64_tr_b16 a[76:77], v46 offset:1024
    ds_read_b64_tr_b16 a[78:79], v46 offset:1280
    v_cndmask_b32 v225, v206, 0, s[90:91]
    v_mov_b64 v[226:227], 0
    v_add_f32 v208, v208, v210
    s_waitcnt lgkmcnt(8)
    v_mfma_f32_32x32x16_bf16 v[64:79], a[88:91], v[172:175], v[64:79]
    ds_read_b64_tr_b16 a[80:81], v47 offset:1024
    ds_read_b64_tr_b16 a[82:83], v47 offset:1280
    v_add_f32 v209, v209, v211
    v_add_f32 v208, v208, v209
    v_and_b32 v209, 0xffff0000, v208
    v_sub_f32 v210, v208, v209
    v_mfma_f32_32x32x16_bf16 v[64:79], v[220:223], v[48:51], v[64:79]
    v_cvt_pk_bf16_f32 v209, v209, v209
    v_cvt_pk_bf16_f32 v210, v210, v210
    v_cndmask_b32 v228, v209, v30, s[90:91]
    v_cndmask_b32 v229, v210, 0, s[90:91]
    v_mov_b64 v[230:231], 0
    v_add_f32 v212, v212, v214
    v_mfma_f32_32x32x16_bf16 v[80:95], a[92:95], v[132:135], v[80:95]
    ds_read_b64_tr_b16 a[84:85], v45 offset:17408
    ds_read_b64_tr_b16 a[86:87], v45 offset:17664
    v_add_f32 v213, v213, v215
    v_add_f32 v212, v212, v213
    v_and_b32 v213, 0xffff0000, v212
    s_waitcnt lgkmcnt(8)
    v_mfma_f32_32x32x16_bf16 v[80:95], a[96:99], v[136:139], v[80:95]
    ds_read_b64_tr_b16 a[88:89], v46 offset:17408
    ds_read_b64_tr_b16 a[90:91], v46 offset:17664
    v_sub_f32 v214, v212, v213
    v_cvt_pk_bf16_f32 v213, v213, v213
    v_cvt_pk_bf16_f32 v214, v214, v214
    v_cndmask_b32 v232, v213, v31, s[90:91]
    v_mfma_f32_32x32x16_bf16 v[80:95], a[100:103], v[140:143], v[80:95]
L_pad4:
    s_cbranch_execz L_pad8
    ds_read_b64_tr_b16 a[92:93], v47 offset:17408
    ds_read_b64_tr_b16 a[94:95], v47 offset:17664
    v_cndmask_b32 v233, v214, 0, s[90:91]
    v_mov_b64 v[234:235], 0
    v_mul_f32 v64, v20, v64
    s_waitcnt lgkmcnt(8)
    v_mfma_f32_32x32x16_bf16 v[80:95], a[72:75], v[148:151], v[80:95]
    ds_read_b64_tr_b16 a[96:97], v41 offset:51200
    ds_read_b64_tr_b16 a[98:99], v41 offset:51456
    v_mul_f32 v65, v20, v65
    v_mul_f32 v66, v20, v66
    v_mul_f32 v67, v20, v67
    v_mul_f32 v68, v20, v68
    v_mfma_f32_32x32x16_bf16 v[80:95], a[76:79], v[152:155], v[80:95]
    ds_read_b64_tr_b16 a[100:101], v42 offset:51200
    ds_read_b64_tr_b16 a[102:103], v42 offset:51456
    v_mul_f32 v69, v20, v69
    v_mul_f32 v70, v20, v70
    v_mul_f32 v71, v20, v71
    s_waitcnt lgkmcnt(8)
    v_mfma_f32_32x32x16_bf16 v[80:95], a[80:83], v[156:159], v[80:95]
    ds_read_b64_tr_b16 a[72:73], v43 offset:51200
    ds_read_b64_tr_b16 a[74:75], v43 offset:51456
    v_cvt_pk_bf16_f32 v24, v64, v65
    v_cvt_pk_bf16_f32 v25, v66, v67
    v_cvt_pk_bf16_f32 v26, v68, v69
    v_cvt_pk_bf16_f32 v27, v70, v71
    v_mfma_f32_32x32x16_bf16 v[80:95], a[84:87], v[164:167], v[80:95]
    ds_read_b64_tr_b16 a[76:77], v45 offset:2048
    ds_read_b64_tr_b16 a[78:79], v45 offset:2304
    s_waitcnt vmcnt(0)
    v_cmp_ne_u32 vcc, 1, v8
    s_cbranch_vccnz L_kv_retry
L_kv_ok:
    s_waitcnt lgkmcnt(8)
    v_mfma_f32_32x32x16_bf16 v[80:95], a[88:91], v[168:171], v[80:95]
    ds_read_b64_tr_b16 a[80:81], v46 offset:2048
    ds_read_b64_tr_b16 a[82:83], v46 offset:2304
    buffer_load_dwordx4 a[104:107], v1, s[60:63], s94 offen sc1
    v_mfma_f32_32x32x16_bf16 v[80:95], a[92:95], v[172:175], v[80:95]
    ds_read_b64_tr_b16 a[84:85], v47 offset:2048
    ds_read_b64_tr_b16 a[86:87], v47 offset:2304
    global_load_dwordx4 a[0:3], v248, s[60:61] offset:-4096 sc1
    v_mfma_f32_32x32x16_bf16 v[80:95], v[224:227], v[48:51], v[80:95]
    ds_write_b128 v62, v[24:27] offset:0
    v_mul_f32 v72, v20, v72
    v_mul_f32 v73, v20, v73
    v_mul_f32 v74, v20, v74
    v_mul_f32 v75, v20, v75
    v_mul_f32 v76, v20, v76
    s_waitcnt lgkmcnt(9)
    v_mfma_f32_32x32x16_bf16 v[96:111], a[96:99], v[132:135], v[96:111]
    ds_read_b64_tr_b16 a[88:89], v45 offset:18432
    ds_read_b64_tr_b16 a[90:91], v45 offset:18688
    global_load_dwordx4 a[4:7], v3, s[60:61] offset:-3072 sc1
    v_mul_f32 v77, v20, v77
    v_mul_f32 v78, v20, v78
    v_mul_f32_e64 v79, v20, v79
    v_mfma_f32_32x32x16_bf16 v[96:111], a[100:103], v[136:139], v[96:111]
    ds_read_b64_tr_b16 a[92:93], v46 offset:18432
    ds_read_b64_tr_b16 a[94:95], v46 offset:18688
    global_load_dwordx4 a[8:11], v3, s[60:61] offset:-2560 sc1
    v_cvt_pk_bf16_f32 v28, v72, v73
    v_cvt_pk_bf16_f32 v29, v74, v75
    s_waitcnt lgkmcnt(9)
    v_mfma_f32_32x32x16_bf16 v[96:111], a[72:75], v[140:143], v[96:111]
    ds_read_b64_tr_b16 a[96:97], v47 offset:18432
    ds_read_b64_tr_b16 a[98:99], v47 offset:18688
    global_load_dwordx4 a[12:15], v248, s[60:61] offset:-2048 sc1
    v_cvt_pk_bf16_f32 v30, v76, v77
    v_cvt_pk_bf16_f32 v31, v78, v79
    v_mfma_f32_32x32x16_bf16 v[96:111], a[76:79], v[148:151], v[96:111]
    ds_read_b64_tr_b16 a[100:101], v41 offset:52224
    ds_read_b64_tr_b16 a[102:103], v41 offset:52480
    global_load_dwordx4 a[16:19], v3, s[60:61] offset:-1024 sc1
    s_waitcnt lgkmcnt(9)
    v_mfma_f32_32x32x16_bf16 v[96:111], a[80:83], v[152:155], v[96:111]
    ds_read_b64_tr_b16 a[72:73], v42 offset:52224
    ds_read_b64_tr_b16 a[74:75], v42 offset:52480
    global_load_dwordx4 a[20:23], v3, s[60:61] offset:-512 sc1
    ds_write_b128 v62, v[28:31] offset:4096
    v_mfma_f32_32x32x16_bf16 v[96:111], a[84:87], v[156:159], v[96:111]
    ds_read_b64_tr_b16 a[76:77], v43 offset:52224
    ds_read_b64_tr_b16 a[78:79], v43 offset:52480
    v_mul_f32 v80, v80, |v80|
    v_mul_f32 v81, v81, |v81|
    v_cvt_pk_bf16_f32 v80, v80, v81
    s_waitcnt lgkmcnt(9)
    v_mfma_f32_32x32x16_bf16 v[96:111], a[88:91], v[164:167], v[96:111]
    ds_read_b64_tr_b16 a[80:81], v45 offset:3072
    ds_read_b64_tr_b16 a[82:83], v45 offset:3328
    v_pk_max_i16 v176, v80, 0
    v_mul_f32 v82, v82, |v82|
    v_mul_f32 v83, v83, |v83|
    v_cvt_pk_bf16_f32 v82, v82, v83
    v_mfma_f32_32x32x16_bf16 v[96:111], a[92:95], v[168:171], v[96:111]
    ds_read_b64_tr_b16 a[84:85], v46 offset:3072
    ds_read_b64_tr_b16 a[86:87], v46 offset:3328
    v_pk_max_i16 v177, v82, 0
    v_mul_f32 v84, v84, |v84|
    v_mul_f32 v85, v85, |v85|
    s_waitcnt lgkmcnt(9)
    v_mfma_f32_32x32x16_bf16 v[96:111], a[96:99], v[172:175], v[96:111]
    ds_read_b64_tr_b16 a[88:89], v47 offset:3072
    ds_read_b64_tr_b16 a[90:91], v47 offset:3328
    v_cvt_pk_bf16_f32 v84, v84, v85
    v_pk_max_i16 v178, v84, 0
    s_waitcnt lgkmcnt(8)
    s_barrier
    ds_read_b128 v[200:203], v13 offset:0
    v_mfma_f32_32x32x16_bf16 v[96:111], v[228:231], v[48:51], v[96:111]
    ds_read_b128 v[204:207], v13 offset:1024
    ds_read_b128 v[208:211], v14 offset:0
    ds_read_b128 v[212:215], v14 offset:1024
    ds_read_b32 v11, v22
    ds_read_b32 v12, v22 offset:256
    v_mul_f32 v86, v86, |v86|
    v_mfma_f32_32x32x16_bf16 v[112:127], a[100:103], v[132:135], v[112:127]
    ds_read_b64_tr_b16 a[92:93], v45 offset:19456
    ds_read_b64_tr_b16 a[94:95], v45 offset:19712
    v_mul_f32 v87, v87, |v87|
    v_cvt_pk_bf16_f32 v86, v86, v87
    v_pk_max_i16 v179, v86, 0
    s_waitcnt lgkmcnt(14)
    v_mfma_f32_32x32x16_bf16 v[112:127], a[72:75], v[136:139], v[112:127]
    ds_read_b64_tr_b16 a[96:97], v46 offset:19456
    ds_read_b64_tr_b16 a[98:99], v46 offset:19712
    v_mul_f32 v88, v88, |v88|
    v_mul_f32 v89, v89, |v89|
    v_cvt_pk_bf16_f32 v88, v88, v89
    v_pk_max_i16 v180, v88, 0
    v_mfma_f32_32x32x16_bf16 v[112:127], a[76:79], v[140:143], v[112:127]
    ds_read_b64_tr_b16 a[100:101], v47 offset:19456
    ds_read_b64_tr_b16 a[102:103], v47 offset:19712
    v_mul_f32 v90, v90, |v90|
    v_mul_f32 v91, v91, |v91|
    v_cvt_pk_bf16_f32 v90, v90, v91
    s_waitcnt lgkmcnt(14)
    v_mfma_f32_32x32x16_bf16 v[112:127], a[80:83], v[148:151], v[112:127]
    v_pk_max_i16 v181, v90, 0
    v_mul_f32 v92, v92, |v92|
    v_mul_f32 v93, v93, |v93|
    v_cvt_pk_bf16_f32 v92, v92, v93
    v_pk_max_i16 v182, v92, 0
    v_mul_f32 v94, v94, |v94|
    v_mfma_f32_32x32x16_bf16 v[112:127], a[84:87], v[152:155], v[112:127]
    v_mul_f32 v95, v95, |v95|
    v_cvt_pk_bf16_f32 v94, v94, v95
    v_pk_max_i16 v183, v94, 0
    v_mul_f32 v96, v96, |v96|
    v_mul_f32 v97, v97, |v97|
    s_waitcnt lgkmcnt(4)
    v_mfma_f32_32x32x16_bf16 v[112:127], a[88:91], v[156:159], v[112:127]
    v_cvt_pk_bf16_f32 v96, v96, v97
    v_pk_max_i16 v184, v96, 0
    v_mul_f32 v98, v98, |v98|
    v_mul_f32 v99, v99, |v99|
    v_cvt_pk_bf16_f32 v98, v98, v99
    v_pk_max_i16 v185, v98, 0
    v_mfma_f32_32x32x16_bf16 v[112:127], a[92:95], v[164:167], v[112:127]
    v_mul_f32 v100, v100, |v100|
    v_mul_f32 v101, v101, |v101|
    v_cvt_pk_bf16_f32 v100, v100, v101
    v_pk_max_i16 v186, v100, 0
    v_mul_f32 v102, v102, |v102|
    s_waitcnt lgkmcnt(0)
    v_mfma_f32_32x32x16_bf16 v[112:127], a[96:99], v[168:171], v[112:127]
    v_mul_f32 v103, v103, |v103|
    v_cvt_pk_bf16_f32 v102, v102, v103
    v_pk_max_i16 v187, v102, 0
    v_mul_f32 v104, v104, |v104|
    v_mul_f32 v105, v105, |v105|
    v_cvt_pk_bf16_f32 v104, v104, v105
    v_mfma_f32_32x32x16_bf16 v[112:127], a[100:103], v[172:175], v[112:127]
    v_pk_max_i16 v188, v104, 0
    v_mul_f32 v106, v106, |v106|
    v_mul_f32 v107, v107, |v107|
    v_cvt_pk_bf16_f32 v106, v106, v107
    v_pk_max_i16 v189, v106, 0
    v_mfma_f32_32x32x16_bf16 v[112:127], v[232:235], v[48:51], v[112:127]
    v_mul_f32 v108, v108, |v108|
    v_mul_f32 v109, v109, |v109|
    v_cvt_pk_bf16_f32 v108, v108, v109
    v_pk_max_i16 v190, v108, 0
    v_mul_f32 v110, v110, |v110|
    v_mul_f32 v111, v111, |v111|
    v_cvt_pk_bf16_f32 v110, v110, v111
    v_pk_max_i16 v191, v110, 0
    s_waitcnt lgkmcnt(0)
    s_waitcnt vmcnt(6)
    v_mfma_f32_32x32x16_bf16 v[16:31], a[104:107], v[200:203], 0
    v_accvgpr_read_b32 v13, a144
    v_accvgpr_read_b32 v14, a141
    v_mfma_f32_32x32x16_bf16 v[32:47], a[104:107], v[204:207], 0
    v_mul_f32 v112, v112, |v112|
    v_mul_f32 v113, v113, |v113|
    v_cvt_pk_bf16_f32 v112, v112, v113
    v_pk_max_i16 v192, v112, 0
    v_mul_f32 v114, v114, |v114|
    v_mul_f32 v115, v115, |v115|
    v_mfma_f32_32x32x16_bf16 v[48:63], a[104:107], v[208:211], 0
    v_cvt_pk_bf16_f32 v114, v114, v115
    v_pk_max_i16 v193, v114, 0
    v_mul_f32 v116, v116, |v116|
    v_mul_f32 v117, v117, |v117|
    v_cvt_pk_bf16_f32 v116, v116, v117
    v_pk_max_i16 v194, v116, 0
    v_mfma_f32_32x32x16_bf16 v[64:79], a[104:107], v[212:215], 0
    v_mul_f32 v118, v118, |v118|
    v_mul_f32 v119, v119, |v119|
    v_cvt_pk_bf16_f32 v118, v118, v119
    v_pk_max_i16 v195, v118, 0
    v_mul_f32 v120, v120, |v120|
    v_mul_f32 v121, v121, |v121|
    v_mfma_f32_32x32x16_bf16 v[80:95], v[238:241], v[242:245], 0
    v_cvt_pk_bf16_f32 v120, v120, v121
    v_pk_max_i16 v196, v120, 0
    v_mul_f32 v122, v122, |v122|
    v_mul_f32 v123, v123, |v123|
    v_cvt_pk_bf16_f32 v122, v122, v123
    v_pk_max_i16 v197, v122, 0
    v_mfma_f32_32x32x16_bf16 v[96:111], v[238:241], v[242:245], 0
    v_mul_f32 v124, v124, |v124|
    v_mul_f32 v125, v125, |v125|
    v_cvt_pk_bf16_f32 v124, v124, v125
    v_pk_max_i16 v198, v124, 0
    v_mul_f32 v126, v126, |v126|
    v_mul_f32 v127, v127, |v127|
    v_cvt_pk_bf16_f32 v126, v126, v127
    v_pk_max_i16 v199, v126, 0
    v_max3_f32 v160, v16, v17, v18
    v_max3_f32 v161, v19, v20, v21
    v_max3_f32 v160, v22, v23, v160
    v_max3_f32 v161, v24, v25, v161
    v_max3_f32 v160, v26, v27, v160
    v_max3_f32 v161, v28, v29, v161
    v_max3_f32 v160, v30, v31, v160
    v_mfma_f32_32x32x16_bf16 v[112:127], v[238:241], v[242:245], 0
    v_max_f32_e64 v160, v160, v161
    v_max3_f32 v162, v32, v33, v34
    v_max3_f32 v163, v35, v36, v37
    v_max3_f32 v162, v38, v39, v162
    v_max3_f32 v163, v40, v41, v163
    v_max3_f32 v162, v42, v43, v162
    v_max3_f32 v163, v44, v45, v163
    v_max3_f32 v162, v46, v47, v162
    v_mfma_f32_32x32x16_bf16 v[128:143], v[238:241], v[242:245], 0
    v_max_f32 v162, v162, v163
    s_nop 1
    v_permlane32_swap_b32 v160, v162
    v_max_f32 v160, v160, v162
    v_sub_f32 v160, 0xc2cc0000, v160
    v_and_b32 v161, 0xffff0000, v160
    v_sub_f32 v160, v160, v161
    v_cvt_pk_bf16_f32 v236, v161, v160
    s_nop 1
    v_mfma_f32_32x32x16_bf16 v[16:31], v[238:241], v[236:239], 0
    v_max3_f32 v160, v48, v49, v50
    v_max3_f32 v161, v51, v52, v53
    v_max3_f32 v160, v54, v55, v160
    v_max3_f32 v161, v56, v57, v161
    v_max3_f32 v160, v58, v59, v160
    v_max3_f32 v161, v60, v61, v161
    v_max3_f32 v160, v62, v63, v160
    v_mfma_f32_32x32x16_bf16 v[32:47], v[242:245], v[236:239], 0
    v_max_f32_e64 v160, v160, v161
    v_max3_f32 v162, v64, v65, v66
    v_max3_f32 v163, v67, v68, v69
    v_max3_f32 v162, v70, v71, v162
    v_max3_f32 v163, v72, v73, v163
    v_max3_f32 v162, v74, v75, v162
    v_max3_f32 v163, v76, v77, v163
    v_max3_f32 v162, v78, v79, v162
    s_waitcnt vmcnt(3)
    v_mfma_f32_32x32x16_bf16 v[144:159], a[0:3], v[200:203], v[16:31]
    v_max_f32 v162, v162, v163
    s_nop 1
    v_permlane32_swap_b32 v160, v162
    v_max_f32 v160, v160, v162
    v_sub_f32 v160, 0xc2cc0000, v160
    v_and_b32 v161, 0xffff0000, v160
    v_sub_f32 v160, v160, v161
    v_cvt_pk_bf16_f32 v236, v161, v160
    s_nop 1
    v_mfma_f32_32x32x16_bf16 v[48:63], v[238:241], v[236:239], 0
    v_exp_f32 v144, v144
    v_exp_f32 v145, v145
    v_mfma_f32_32x32x16_bf16 v[64:79], v[242:245], v[236:239], 0
    s_lshl_b32 s11, s2, 2
    global_load_dwordx4 a[24:27], v248, s[60:61] offset:0 sc1
    global_load_dwordx4 a[28:31], v3, s[60:61] offset:1024 sc1
    global_load_dwordx4 a[32:35], v3, s[60:61] offset:1536 sc1
    v_exp_f32 v146, v146
    v_exp_f32 v147, v147
    v_exp_f32 v148, v148
    v_mfma_f32_32x32x16_bf16 v[160:175], a[0:3], v[204:207], v[32:47]
    s_add_u32 s11, s11, s3
    v_exp_f32 v149, v149
    v_exp_f32 v150, v150
    v_exp_f32 v151, v151
    v_exp_f32 v152, v152
    v_exp_f32 v153, v153
    v_smfmac_f32_32x32x32_bf16 v[80:95], a[4:7], v[144:151], v4
    s_lshl_b32 s11, s11, 10
    v_exp_f32 v154, v154
    v_exp_f32 v155, v155
    v_exp_f32 v156, v156
    v_exp_f32 v157, v157
    v_exp_f32 v158, v158
    v_exp_f32 v159, v159
    v_exp_f32 v160, v160
    v_exp_f32 v161, v161
    v_smfmac_f32_32x32x32_bf16 v[80:95], a[8:11], v[152:159], v4
    s_add_u32 s12, s11, 1048576
    v_exp_f32 v162, v162
    v_exp_f32 v163, v163
    v_exp_f32 v164, v164
    v_mfma_f32_32x32x16_bf16 v[144:159], a[0:3], v[208:211], v[48:63]
    s_barrier
    v_exp_f32 v165, v165
    v_exp_f32 v166, v166
    v_exp_f32 v167, v167
    v_exp_f32 v168, v168
    v_exp_f32_e64 v169, v169
    v_smfmac_f32_32x32x32_bf16 v[96:111], a[4:7], v[160:167], v4
    s_sub_u32 s13, 1047552, s11
    global_load_dwordx4 a[36:39], v248, s[60:61] offset:2048 sc1
    global_load_dwordx4 a[40:43], v3, s[60:61] offset:3072 sc1
    global_load_dwordx4 a[44:47], v3, s[60:61] offset:3584 sc1
    v_exp_f32 v170, v170
    v_exp_f32 v171, v171
    v_exp_f32 v172, v172
    v_exp_f32 v173, v173
    v_exp_f32 v174, v174
    v_exp_f32 v175, v175
    v_exp_f32 v144, v144
    v_exp_f32 v145, v145
    v_smfmac_f32_32x32x32_bf16 v[96:111], a[8:11], v[168:175], v4
    v_add_u32 v248, 0x2000, v248
    v_add_u32 v3, v13, v3
    v_exp_f32 v146, v146
    v_exp_f32 v147, v147
    v_exp_f32 v148, v148
    v_mfma_f32_32x32x16_bf16 v[160:175], a[0:3], v[212:215], v[64:79]
    v_exp_f32 v149, v149
    v_exp_f32 v150, v150
    v_exp_f32 v151, v151
    v_exp_f32 v152, v152
    v_exp_f32 v153, v153
    v_smfmac_f32_32x32x32_bf16 v[112:127], a[4:7], v[144:151], v4
    v_exp_f32 v154, v154
    v_exp_f32 v155, v155
    v_exp_f32 v156, v156
    v_exp_f32 v157, v157
    v_exp_f32 v158, v158
    v_exp_f32 v159, v159
    v_exp_f32 v160, v160
    v_exp_f32 v161, v161
    v_smfmac_f32_32x32x32_bf16 v[112:127], a[8:11], v[152:159], v4
    s_waitcnt vmcnt(6)
    v_exp_f32 v162, v162
    v_exp_f32 v163, v163
    v_exp_f32 v164, v164
    v_mfma_f32_32x32x16_bf16 v[144:159], a[12:15], v[200:203], v[16:31]
    s_xor_b32 s50, s8, 0
    v_exp_f32 v165, v165
    v_exp_f32 v166, v166
    v_exp_f32 v167, v167
    v_exp_f32 v168, v168
    v_exp_f32 v169, v169
    v_smfmac_f32_32x32x32_bf16 v[128:143], a[4:7], v[160:167], v4
    s_xor_b32 s51, s8, 262144
    v_exp_f32 v170, v170
    v_exp_f32 v171, v171
    v_exp_f32 v172, v172
    v_exp_f32 v173, v173
    v_exp_f32 v174, v174
    v_exp_f32 v175, v175
    v_exp_f32 v144, v144
    v_exp_f32_e64 v145, v145
    v_smfmac_f32_32x32x32_bf16 v[128:143], a[8:11], v[168:175], v4
    s_xor_b32 s72, s8, 65536
    global_load_dwordx4 a[48:51], v248, s[60:61] offset:-4096 sc1
    global_load_dwordx4 a[52:55], v3, s[60:61] offset:-3072 sc1
    global_load_dwordx4 a[56:59], v3, s[60:61] offset:-2560 sc1
    v_exp_f32 v146, v146
    v_exp_f32 v147, v147
    v_exp_f32 v148, v148
    v_mfma_f32_32x32x16_bf16 v[160:175], a[12:15], v[204:207], v[32:47]
    s_xor_b32 s73, s8, 131072
    v_exp_f32 v149, v149
    v_exp_f32 v150, v150
    v_exp_f32 v151, v151
    v_exp_f32 v152, v152
    v_exp_f32 v153, v153
    v_smfmac_f32_32x32x32_bf16 v[80:95], a[16:19], v[144:151], v4
    s_xor_b32 s74, s8, 196608
    v_exp_f32 v154, v154
    v_exp_f32 v155, v155
    v_exp_f32 v156, v156
    v_exp_f32 v157, v157
    v_exp_f32 v158, v158
    v_exp_f32 v159, v159
    v_exp_f32 v160, v160
    v_exp_f32 v161, v161
    v_smfmac_f32_32x32x32_bf16 v[80:95], a[20:23], v[152:159], v4
    s_xor_b32 s75, s8, 327680
    v_exp_f32 v162, v162
    v_exp_f32 v163, v163
    v_exp_f32 v164, v164
    v_mfma_f32_32x32x16_bf16 v[144:159], a[12:15], v[208:211], v[48:63]
    s_xor_b32 s76, s8, 393216
    v_exp_f32 v165, v165
    v_exp_f32 v166, v166
    v_exp_f32 v167, v167
    v_exp_f32 v168, v168
    v_exp_f32 v169, v169
    v_smfmac_f32_32x32x32_bf16 v[96:111], a[16:19], v[160:167], v4
    s_xor_b32 s77, s8, 458752
    global_load_dwordx4 a[60:63], v248, s[60:61] offset:-2048 sc1
    global_load_dwordx4 a[64:67], v3, s[60:61] offset:-1024 sc1
    global_load_dwordx4 a[68:71], v3, s[60:61] offset:-512 sc1
    v_exp_f32 v170, v170
    v_exp_f32 v171, v171
    v_exp_f32 v172, v172
    v_exp_f32 v173, v173
    v_exp_f32 v174, v174
    v_exp_f32 v175, v175
    v_exp_f32 v144, v144
    v_exp_f32 v145, v145
    v_smfmac_f32_32x32x32_bf16 v[96:111], a[20:23], v[168:175], v4
    s_xor_b32 s38, s8, 0
    v_exp_f32 v146, v146
    v_exp_f32 v147, v147
    v_exp_f32 v148, v148
    v_mfma_f32_32x32x16_bf16 v[160:175], a[12:15], v[212:215], v[64:79]
    s_xor_b32 s39, s8, 262144
    v_exp_f32 v149, v149
    v_exp_f32 v150, v150
    v_exp_f32 v151, v151
    v_exp_f32 v152, v152
    v_exp_f32 v153, v153
    v_smfmac_f32_32x32x32_bf16 v[112:127], a[16:19], v[144:151], v4
    s_xor_b32 s22, s8, 1048576
    v_exp_f32 v154, v154
    v_exp_f32 v155, v155
    v_exp_f32 v156, v156
    v_exp_f32 v157, v157
    v_exp_f32 v158, v158
    v_exp_f32 v159, v159
    v_exp_f32 v160, v160
    v_exp_f32 v161, v161
    v_smfmac_f32_32x32x32_bf16 v[112:127], a[20:23], v[152:159], v4
    s_waitcnt vmcnt(9)
    v_exp_f32 v162, v162
    v_exp_f32 v163, v163
    v_exp_f32 v164, v164
    v_mfma_f32_32x32x16_bf16 v[144:159], a[24:27], v[200:203], v[16:31]
    s_and_b32 s23, s8, 0x10000
    v_exp_f32 v165, v165
    v_exp_f32 v166, v166
    v_exp_f32 v167, v167
    v_exp_f32 v168, v168
    v_exp_f32 v169, v169
    v_smfmac_f32_32x32x32_bf16 v[128:143], a[16:19], v[160:167], v4
    s_xor_b32 s23, s23, 1310720
    v_exp_f32 v170, v170
    v_exp_f32 v171, v171
    v_exp_f32 v172, v172
    v_exp_f32 v173, v173
    v_exp_f32 v174, v174
    v_exp_f32 v175, v175
    v_exp_f32 v144, v144
    v_exp_f32 v145, v145
    v_smfmac_f32_32x32x32_bf16 v[128:143], a[20:23], v[168:175], v4
    s_xor_b32 s24, s8, 65536
    global_load_dwordx4 a[0:3], v248, s[60:61] offset:0 sc1
    global_load_dwordx4 a[4:7], v3, s[60:61] offset:1024 sc1
    global_load_dwordx4 a[8:11], v3, s[60:61] offset:1536 sc1
    v_exp_f32 v146, v146
    v_exp_f32 v147, v147
    v_exp_f32 v148, v148
    v_mfma_f32_32x32x16_bf16 v[160:175], a[24:27], v[204:207], v[32:47]
    s_xor_b32 s25, s8, 131072
    v_exp_f32 v149, v149
    v_exp_f32 v150, v150
    v_exp_f32 v151, v151
    v_exp_f32 v152, v152
    v_exp_f32 v153, v153
    v_smfmac_f32_32x32x32_bf16 v[80:95], a[28:31], v[144:151], v4
    s_xor_b32 s26, s8, 196608
    v_exp_f32 v154, v154
    v_exp_f32 v155, v155
    v_exp_f32 v156, v156
    v_exp_f32 v157, v157
    v_exp_f32 v158, v158
    v_exp_f32 v159, v159
    v_exp_f32 v160, v160
    v_exp_f32 v161, v161
    v_smfmac_f32_32x32x32_bf16 v[80:95], a[32:35], v[152:159], v4
    s_xor_b32 s27, s8, 524288
    v_exp_f32 v162, v162
    v_exp_f32 v163, v163
    v_exp_f32 v164, v164
    v_mfma_f32_32x32x16_bf16 v[144:159], a[24:27], v[208:211], v[48:63]
    s_xor_b32 s28, s8, 327680
    v_exp_f32 v165, v165
    v_exp_f32 v166, v166
    v_exp_f32 v167, v167
    v_exp_f32 v168, v168
    v_exp_f32 v169, v169
    v_smfmac_f32_32x32x32_bf16 v[96:111], a[28:31], v[160:167], v4
    s_xor_b32 s29, s8, 393216
    global_load_dwordx4 a[12:15], v248, s[60:61] offset:2048 sc1
    global_load_dwordx4 a[16:19], v3, s[60:61] offset:3072 sc1
    global_load_dwordx4 a[20:23], v3, s[60:61] offset:3584 sc1
    v_exp_f32 v170, v170
    v_exp_f32 v171, v171
    v_exp_f32 v172, v172
    v_exp_f32 v173, v173
    v_exp_f32 v174, v174
    v_exp_f32 v175, v175
    v_exp_f32 v144, v144
    v_exp_f32 v145, v145
    v_smfmac_f32_32x32x32_bf16 v[96:111], a[32:35], v[168:175], v4
    s_xor_b32 s30, s8, 458752
    v_add_u32 v248, 0x2000, v248
    v_add_u32 v3, v13, v3
    v_exp_f32 v146, v146
    v_exp_f32 v147, v147
    v_exp_f32 v148, v148
    v_mfma_f32_32x32x16_bf16 v[160:175], a[24:27], v[212:215], v[64:79]
    s_xor_b32 s31, s8, 786432
    v_exp_f32 v149, v149
    v_exp_f32 v150, v150
    v_exp_f32 v151, v151
    v_exp_f32 v152, v152
    v_exp_f32 v153, v153
    v_smfmac_f32_32x32x32_bf16 v[112:127], a[28:31], v[144:151], v4
    s_xor_b32 s32, s8, 589824
    v_exp_f32 v154, v154
    v_exp_f32 v155, v155
    v_exp_f32 v156, v156
    v_exp_f32 v157, v157
    v_exp_f32 v158, v158
    v_exp_f32 v159, v159
    v_exp_f32 v160, v160
    v_exp_f32 v161, v161
    v_smfmac_f32_32x32x32_bf16 v[112:127], a[32:35], v[152:159], v4
    s_waitcnt vmcnt(12)
    v_exp_f32 v162, v162
    v_exp_f32 v163, v163
    v_exp_f32 v164, v164
    v_mfma_f32_32x32x16_bf16 v[144:159], a[36:39], v[200:203], v[16:31]
    s_xor_b32 s33, s8, 655360
    v_exp_f32 v165, v165
    v_exp_f32 v166, v166
    v_exp_f32 v167, v167
    v_exp_f32 v168, v168
    v_exp_f32 v169, v169
    v_smfmac_f32_32x32x32_bf16 v[128:143], a[28:31], v[160:167], v4
    s_xor_b32 s34, s8, 720896
    v_exp_f32 v170, v170
    v_exp_f32 v171, v171
    v_exp_f32 v172, v172
    v_exp_f32 v173, v173
    v_exp_f32 v174, v174
    v_exp_f32 v175, v175
    v_exp_f32 v144, v144
    v_exp_f32 v145, v145
    v_smfmac_f32_32x32x32_bf16 v[128:143], a[32:35], v[168:175], v4
    s_xor_b32 s35, s8, 851968
    global_load_dwordx4 a[24:27], v248, s[60:61] offset:-4096 sc1
    global_load_dwordx4 a[28:31], v3, s[60:61] offset:-3072 sc1
    global_load_dwordx4 a[32:35], v3, s[60:61] offset:-2560 sc1
    v_exp_f32 v146, v146
    v_exp_f32 v147, v147
    v_exp_f32 v148, v148
    v_mfma_f32_32x32x16_bf16 v[160:175], a[36:39], v[204:207], v[32:47]
    s_xor_b32 s44, s8, 917504
    v_exp_f32 v149, v149
    v_exp_f32 v150, v150
    v_exp_f32 v151, v151
    v_exp_f32 v152, v152
    v_exp_f32 v153, v153
    v_smfmac_f32_32x32x32_bf16 v[80:95], a[40:43], v[144:151], v4
    s_xor_b32 s45, s8, 983040
    v_exp_f32 v154, v154
    v_exp_f32 v155, v155
    v_exp_f32 v156, v156
    v_exp_f32 v157, v157
    v_exp_f32 v158, v158
    v_exp_f32 v159, v159
    v_exp_f32 v160, v160
    v_exp_f32 v161, v161
    v_smfmac_f32_32x32x32_bf16 v[80:95], a[44:47], v[152:159], v4
    s_xor_b32 s46, s8, 1114112
    v_exp_f32 v162, v162
    v_exp_f32 v163, v163
    v_exp_f32 v164, v164
    v_mfma_f32_32x32x16_bf16 v[144:159], a[36:39], v[208:211], v[48:63]
    s_mul_i32 s16, s3, 43
    v_exp_f32 v165, v165
    v_exp_f32 v166, v166
    v_exp_f32 v167, v167
    v_exp_f32 v168, v168
    v_exp_f32 v169, v169
    v_smfmac_f32_32x32x32_bf16 v[96:111], a[40:43], v[160:167], v4
    s_add_u32 s16, s16, 45
    buffer_load_dwordx4 a[72:75], v1, s[56:59], s13 offen
    buffer_load_dwordx4 a[76:79], v1, s[52:55], s11 offen
    buffer_load_dwordx4 a[80:83], v1, s[52:55], s12 offen
    v_exp_f32 v170, v170
    v_exp_f32 v171, v171
    v_exp_f32 v172, v172
    v_exp_f32 v173, v173
    v_exp_f32 v174, v174
    v_exp_f32 v175, v175
    v_exp_f32 v144, v144
    v_exp_f32 v145, v145
    v_smfmac_f32_32x32x32_bf16 v[96:111], a[44:47], v[168:175], v4
    s_lshr_b32 s16, s16, 1
    v_exp_f32 v146, v146
    v_exp_f32 v147, v147
    v_exp_f32 v148, v148
    v_mfma_f32_32x32x16_bf16 v[160:175], a[36:39], v[212:215], v[64:79]
    s_lshl_b32 s66, s16, 16
    v_exp_f32 v149, v149
    v_exp_f32 v150, v150
    v_exp_f32 v151, v151
    v_exp_f32 v152, v152
    v_exp_f32 v153, v153
    v_smfmac_f32_32x32x32_bf16 v[112:127], a[40:43], v[144:151], v4
    s_xor_b32 s47, s8, 1179648
    v_exp_f32 v154, v154
    v_exp_f32 v155, v155
    v_exp_f32 v156, v156
    v_exp_f32 v157, v157
    v_exp_f32 v158, v158
    v_exp_f32 v159, v159
    v_exp_f32 v160, v160
    v_exp_f32 v161, v161
    v_smfmac_f32_32x32x32_bf16 v[112:127], a[44:47], v[152:159], v4
    s_waitcnt vmcnt(15)
    v_exp_f32 v162, v162
    v_exp_f32 v163, v163
    v_exp_f32 v164, v164
    v_mfma_f32_32x32x16_bf16 v[144:159], a[48:51], v[200:203], v[16:31]
    s_xor_b32 s48, s8, 1245184
    v_exp_f32 v165, v165
    v_exp_f32 v166, v166
    v_exp_f32 v167, v167
    v_exp_f32 v168, v168
    v_exp_f32 v169, v169
    v_smfmac_f32_32x32x32_bf16 v[128:143], a[40:43], v[160:167], v4
    s_xor_b32 s49, s23, 65536
    v_exp_f32 v170, v170
    v_exp_f32 v171, v171
    v_exp_f32 v172, v172
    v_exp_f32 v173, v173
    v_exp_f32 v174, v174
    v_exp_f32 v175, v175
    v_exp_f32 v144, v144
    v_exp_f32 v145, v145
    v_smfmac_f32_32x32x32_bf16 v[128:143], a[44:47], v[168:175], v4
    global_load_dwordx4 a[36:39], v248, s[60:61] offset:-2048 sc1
    global_load_dwordx4 a[40:43], v3, s[60:61] offset:-1024 sc1
    global_load_dwordx4 a[44:47], v3, s[60:61] offset:-512 sc1
    v_exp_f32 v146, v146
    v_exp_f32 v147, v147
    v_exp_f32 v148, v148
    v_mfma_f32_32x32x16_bf16 v[160:175], a[48:51], v[204:207], v[32:47]
L_pad5:
    s_cbranch_execz L_pad9
    v_exp_f32 v149, v149
    v_exp_f32 v150, v150
    v_exp_f32 v151, v151
    v_exp_f32 v152, v152
    v_exp_f32 v153, v153
    v_smfmac_f32_32x32x32_bf16 v[80:95], a[52:55], v[144:151], v4
    v_exp_f32 v154, v154
    v_exp_f32 v155, v155
    v_exp_f32 v156, v156
    v_exp_f32 v157, v157
    v_exp_f32 v158, v158
    v_exp_f32 v159, v159
    v_exp_f32 v160, v160
    v_exp_f32 v161, v161
    v_smfmac_f32_32x32x32_bf16 v[80:95], a[56:59], v[152:159], v4
    v_exp_f32 v162, v162
    v_exp_f32 v163, v163
    v_exp_f32 v164, v164
    v_mfma_f32_32x32x16_bf16 v[144:159], a[48:51], v[208:211], v[48:63]
    v_exp_f32 v165, v165
    v_exp_f32 v166, v166
    v_exp_f32 v167, v167
    v_exp_f32 v168, v168
    v_exp_f32 v169, v169
    v_smfmac_f32_32x32x32_bf16 v[96:111], a[52:55], v[160:167], v4
    v_exp_f32 v170, v170
    v_exp_f32 v171, v171
    v_exp_f32 v172, v172
    v_exp_f32 v173, v173
    v_exp_f32 v174, v174
    v_exp_f32 v175, v175
    v_exp_f32 v144, v144
    v_exp_f32 v145, v145
    v_smfmac_f32_32x32x32_bf16 v[96:111], a[56:59], v[168:175], v4
    v_exp_f32 v146, v146
    v_exp_f32 v147, v147
    v_exp_f32 v148, v148
    v_mfma_f32_32x32x16_bf16 v[160:175], a[48:51], v[212:215], v[64:79]
    v_exp_f32 v149, v149
    v_exp_f32 v150, v150
    v_exp_f32 v151, v151
    v_exp_f32 v152, v152
    v_exp_f32 v153, v153
    v_smfmac_f32_32x32x32_bf16 v[112:127], a[52:55], v[144:151], v4
    v_exp_f32 v154, v154
    v_exp_f32 v155, v155
    v_exp_f32 v156, v156
    v_exp_f32 v157, v157
    v_exp_f32 v158, v158
    v_exp_f32 v159, v159
    v_exp_f32 v160, v160
    v_exp_f32 v161, v161
    v_smfmac_f32_32x32x32_bf16 v[112:127], a[56:59], v[152:159], v4
    s_waitcnt vmcnt(15)
    v_exp_f32 v162, v162
    v_exp_f32 v163, v163
    v_exp_f32 v164, v164
    v_mfma_f32_32x32x16_bf16 v[144:159], a[60:63], v[200:203], v[16:31]
    v_exp_f32 v165, v165
    v_exp_f32 v166, v166
    v_exp_f32 v167, v167
    v_exp_f32 v168, v168
    v_exp_f32 v169, v169
    v_smfmac_f32_32x32x32_bf16 v[128:143], a[52:55], v[160:167], v4
    v_exp_f32 v170, v170
    v_exp_f32 v171, v171
    v_exp_f32 v172, v172
    v_exp_f32 v173, v173
    v_exp_f32 v174, v174
    v_exp_f32 v175, v175
    v_exp_f32 v144, v144
    v_exp_f32 v145, v145
    v_smfmac_f32_32x32x32_bf16 v[128:143], a[56:59], v[168:175], v4
    global_load_dwordx4 a[48:51], v248, s[60:61] offset:0 sc1
    global_load_dwordx4 a[52:55], v3, s[60:61] offset:1024 sc1
    global_load_dwordx4 a[56:59], v3, s[60:61] offset:1536 sc1
    v_exp_f32 v146, v146
    v_exp_f32 v147, v147
    v_exp_f32 v148, v148
    v_mfma_f32_32x32x16_bf16 v[160:175], a[60:63], v[204:207], v[32:47]
    v_exp_f32 v149, v149
    v_exp_f32 v150, v150
    v_exp_f32 v151, v151
    v_exp_f32 v152, v152
    v_exp_f32 v153, v153
    v_smfmac_f32_32x32x32_bf16 v[80:95], a[64:67], v[144:151], v4
    v_exp_f32 v154, v154
    v_exp_f32 v155, v155
    v_exp_f32 v156, v156
    v_exp_f32 v157, v157
    v_exp_f32 v158, v158
    v_exp_f32 v159, v159
    v_exp_f32 v160, v160
    v_exp_f32 v161, v161
    v_smfmac_f32_32x32x32_bf16 v[80:95], a[68:71], v[152:159], v4
    v_exp_f32 v162, v162
    v_exp_f32 v163, v163
    v_exp_f32 v164, v164
    v_mfma_f32_32x32x16_bf16 v[144:159], a[60:63], v[208:211], v[48:63]
    v_exp_f32 v165, v165
    v_exp_f32 v166, v166
    v_exp_f32 v167, v167
    v_exp_f32 v168, v168
    v_exp_f32 v169, v169
    v_smfmac_f32_32x32x32_bf16 v[96:111], a[64:67], v[160:167], v4
    v_exp_f32 v170, v170
    v_exp_f32 v171, v171
    v_exp_f32 v172, v172
    v_exp_f32 v173, v173
    v_exp_f32 v174, v174
    v_exp_f32 v175, v175
    v_exp_f32 v144, v144
    v_exp_f32 v145, v145
    v_smfmac_f32_32x32x32_bf16 v[96:111], a[68:71], v[168:175], v4
    v_exp_f32 v146, v146
    v_exp_f32 v147, v147
    v_exp_f32 v148, v148
    v_mfma_f32_32x32x16_bf16 v[160:175], a[60:63], v[212:215], v[64:79]
    v_exp_f32 v149, v149
    v_exp_f32 v150, v150
    v_exp_f32 v151, v151
    v_exp_f32 v152, v152
    v_exp_f32 v153, v153
    v_smfmac_f32_32x32x32_bf16 v[112:127], a[64:67], v[144:151], v4
    v_exp_f32 v154, v154
    v_exp_f32 v155, v155
    v_exp_f32 v156, v156
    v_exp_f32 v157, v157
    v_exp_f32 v158, v158
    v_exp_f32 v159, v159
    v_exp_f32 v160, v160
    v_exp_f32 v161, v161
    v_smfmac_f32_32x32x32_bf16 v[112:127], a[68:71], v[152:159], v4
    s_waitcnt vmcnt(15)
    v_exp_f32 v162, v162
    v_exp_f32 v163, v163
    v_exp_f32 v164, v164
    v_mfma_f32_32x32x16_bf16 v[144:159], a[0:3], v[200:203], v[16:31]
    v_exp_f32 v165, v165
    v_exp_f32 v166, v166
    v_exp_f32 v167, v167
    v_exp_f32 v168, v168
    v_exp_f32 v169, v169
    v_smfmac_f32_32x32x32_bf16 v[128:143], a[64:67], v[160:167], v4
    v_exp_f32 v170, v170
    v_exp_f32 v171, v171
    v_exp_f32 v172, v172
    v_exp_f32 v173, v173
    v_exp_f32 v174, v174
    v_exp_f32 v175, v175
    v_exp_f32 v144, v144
    v_exp_f32 v145, v145
    v_smfmac_f32_32x32x32_bf16 v[128:143], a[68:71], v[168:175], v4
    s_add_u32 m0, s96, 0
    global_load_dwordx4 a[60:63], v248, s[60:61] offset:2048 sc1
    global_load_dwordx4 a[64:67], v3, s[60:61] offset:3072 sc1
    global_load_dwordx4 a[68:71], v3, s[60:61] offset:3584 sc1
    v_exp_f32 v146, v146
    v_exp_f32 v147, v147
    v_exp_f32 v148, v148
    v_mfma_f32_32x32x16_bf16 v[160:175], a[0:3], v[204:207], v[32:47]
    s_add_u32 s78, s56, s50
    v_add_u32 v248, 0x2000, v248
    v_add_u32 v3, v13, v3
    v_exp_f32 v149, v149
    v_exp_f32 v150, v150
    v_exp_f32 v151, v151
    v_exp_f32 v152, v152
    v_exp_f32 v153, v153
    v_smfmac_f32_32x32x32_bf16 v[80:95], a[4:7], v[144:151], v4
    s_addc_u32 s79, s57, 0
    v_exp_f32 v154, v154
    v_exp_f32 v155, v155
    v_exp_f32 v156, v156
    v_exp_f32 v157, v157
    v_exp_f32 v158, v158
    v_exp_f32 v159, v159
    v_exp_f32 v160, v160
    v_exp_f32 v161, v161
    v_smfmac_f32_32x32x32_bf16 v[80:95], a[8:11], v[152:159], v4
    v_exp_f32 v162, v162
    v_exp_f32 v163, v163
    v_exp_f32 v164, v164
    v_mfma_f32_32x32x16_bf16 v[144:159], a[0:3], v[208:211], v[48:63]
    v_exp_f32 v165, v165
    v_exp_f32 v166, v166
    v_exp_f32 v167, v167
    v_exp_f32 v168, v168
    v_exp_f32 v169, v169
    v_smfmac_f32_32x32x32_bf16 v[96:111], a[4:7], v[160:167], v4
    global_load_lds_dwordx4 v5, s[78:79]
    global_load_lds_dwordx4 v7, s[78:79] offset:1024
    v_exp_f32 v170, v170
    v_exp_f32 v171, v171
    v_exp_f32 v172, v172
    v_exp_f32 v173, v173
    v_exp_f32 v174, v174
    v_exp_f32 v175, v175
    v_exp_f32 v144, v144
    v_exp_f32 v145, v145
    v_smfmac_f32_32x32x32_bf16 v[96:111], a[8:11], v[168:175], v4
    v_exp_f32 v146, v146
    v_exp_f32 v147, v147
    v_exp_f32 v148, v148
    v_mfma_f32_32x32x16_bf16 v[160:175], a[0:3], v[212:215], v[64:79]
    v_exp_f32 v149, v149
    v_exp_f32 v150, v150
    v_exp_f32 v151, v151
    v_exp_f32 v152, v152
    v_exp_f32 v153, v153
    v_smfmac_f32_32x32x32_bf16 v[112:127], a[4:7], v[144:151], v4
    v_exp_f32 v154, v154
    v_exp_f32 v155, v155
    v_exp_f32 v156, v156
    v_exp_f32 v157, v157
    v_exp_f32 v158, v158
    v_exp_f32 v159, v159
    v_exp_f32 v160, v160
    v_exp_f32 v161, v161
    v_smfmac_f32_32x32x32_bf16 v[112:127], a[8:11], v[152:159], v4
    s_waitcnt vmcnt(17)
    v_exp_f32 v162, v162
    v_exp_f32 v163, v163
    v_exp_f32 v164, v164
    v_mfma_f32_32x32x16_bf16 v[144:159], a[12:15], v[200:203], v[16:31]
    v_exp_f32 v165, v165
    v_exp_f32 v166, v166
    v_exp_f32 v167, v167
    v_exp_f32 v168, v168
    v_exp_f32 v169, v169
    v_smfmac_f32_32x32x32_bf16 v[128:143], a[4:7], v[160:167], v4
    v_exp_f32 v170, v170
    v_exp_f32 v171, v171
    v_exp_f32 v172, v172
    v_exp_f32 v173, v173
    v_exp_f32 v174, v174
    v_exp_f32 v175, v175
    v_exp_f32 v144, v144
    v_exp_f32 v145, v145
    v_smfmac_f32_32x32x32_bf16 v[128:143], a[8:11], v[168:175], v4
    s_add_u32 s100, s64, s84
    global_load_dwordx4 a[0:3], v248, s[60:61] offset:-4096 sc1
    global_load_dwordx4 a[4:7], v3, s[60:61] offset:-3072 sc1
    global_load_dwordx4 a[8:11], v3, s[60:61] offset:-2560 sc1
    v_exp_f32 v146, v146
    v_exp_f32 v147, v147
    v_exp_f32 v148, v148
    v_mfma_f32_32x32x16_bf16 v[160:175], a[12:15], v[204:207], v[32:47]
    s_addc_u32 s101, s65, 0
    v_exp_f32 v149, v149
    v_exp_f32 v150, v150
    v_exp_f32 v151, v151
    v_exp_f32 v152, v152
    v_exp_f32 v153, v153
    v_smfmac_f32_32x32x32_bf16 v[80:95], a[16:19], v[144:151], v4
    s_add_u32 m0, s96, 2048
    v_exp_f32 v154, v154
    v_exp_f32 v155, v155
    v_exp_f32 v156, v156
    v_exp_f32 v157, v157
    v_exp_f32 v158, v158
    v_exp_f32 v159, v159
    v_exp_f32 v160, v160
    v_exp_f32 v161, v161
    v_smfmac_f32_32x32x32_bf16 v[80:95], a[20:23], v[152:159], v4
    s_add_u32 s78, s56, s51
    v_exp_f32 v162, v162
    v_exp_f32 v163, v163
    v_exp_f32 v164, v164
    v_mfma_f32_32x32x16_bf16 v[144:159], a[12:15], v[208:211], v[48:63]
    s_addc_u32 s79, s57, 0
    v_exp_f32 v165, v165
    v_exp_f32 v166, v166
    v_exp_f32 v167, v167
    v_exp_f32 v168, v168
    v_exp_f32 v169, v169
    v_smfmac_f32_32x32x32_bf16 v[96:111], a[16:19], v[160:167], v4
    global_store_dwordx4 v1, v[176:179], s[100:101] sc1
    v_exp_f32 v170, v170
    v_exp_f32 v171, v171
    v_exp_f32 v172, v172
    v_exp_f32 v173, v173
    v_exp_f32 v174, v174
    v_exp_f32 v175, v175
    v_exp_f32 v144, v144
    v_exp_f32 v145, v145
    v_smfmac_f32_32x32x32_bf16 v[96:111], a[20:23], v[168:175], v4
    v_exp_f32 v146, v146
    v_exp_f32 v147, v147
    v_exp_f32 v148, v148
    v_mfma_f32_32x32x16_bf16 v[160:175], a[12:15], v[212:215], v[64:79]
    v_exp_f32 v149, v149
    v_exp_f32 v150, v150
    v_exp_f32 v151, v151
    v_exp_f32 v152, v152
    v_exp_f32 v153, v153
    v_smfmac_f32_32x32x32_bf16 v[112:127], a[16:19], v[144:151], v4
    global_load_lds_dwordx4 v5, s[78:79]
    global_load_lds_dwordx4 v7, s[78:79] offset:1024
    v_exp_f32 v154, v154
    v_exp_f32 v155, v155
    v_exp_f32 v156, v156
    v_exp_f32 v157, v157
    v_exp_f32 v158, v158
    v_exp_f32 v159, v159
    v_exp_f32 v160, v160
    v_exp_f32 v161, v161
    v_smfmac_f32_32x32x32_bf16 v[112:127], a[20:23], v[152:159], v4
    s_waitcnt vmcnt(20)
    v_exp_f32 v162, v162
    v_exp_f32 v163, v163
    v_exp_f32 v164, v164
    v_mfma_f32_32x32x16_bf16 v[144:159], a[24:27], v[200:203], v[16:31]
    v_exp_f32 v165, v165
    v_exp_f32 v166, v166
    v_exp_f32 v167, v167
    v_exp_f32 v168, v168
    v_exp_f32 v169, v169
    v_smfmac_f32_32x32x32_bf16 v[128:143], a[16:19], v[160:167], v4
    v_exp_f32 v170, v170
    v_exp_f32 v171, v171
    v_exp_f32 v172, v172
    v_exp_f32 v173, v173
    v_exp_f32 v174, v174
    v_exp_f32 v175, v175
    v_exp_f32 v144, v144
    v_exp_f32 v145, v145
    v_smfmac_f32_32x32x32_bf16 v[128:143], a[20:23], v[168:175], v4
    s_add_u32 s90, s64, s85
    global_load_dwordx4 a[12:15], v248, s[60:61] offset:-2048 sc1
    global_load_dwordx4 a[16:19], v3, s[60:61] offset:-1024 sc1
    global_load_dwordx4 a[20:23], v3, s[60:61] offset:-512 sc1
    v_exp_f32 v146, v146
    v_exp_f32 v147, v147
    v_exp_f32 v148, v148
    v_mfma_f32_32x32x16_bf16 v[160:175], a[24:27], v[204:207], v[32:47]
    s_addc_u32 s91, s65, 0
    v_exp_f32 v149, v149
    v_exp_f32 v150, v150
    v_exp_f32 v151, v151
    v_exp_f32 v152, v152
    v_exp_f32 v153, v153
    v_smfmac_f32_32x32x32_bf16 v[80:95], a[28:31], v[144:151], v4
    s_add_u32 m0, s96, 4096
    v_exp_f32 v154, v154
    v_exp_f32 v155, v155
    v_exp_f32 v156, v156
    v_exp_f32 v157, v157
    v_exp_f32 v158, v158
    v_exp_f32 v159, v159
    v_exp_f32 v160, v160
    v_exp_f32 v161, v161
    v_smfmac_f32_32x32x32_bf16 v[80:95], a[32:35], v[152:159], v4
    s_add_u32 s78, s56, s72
    v_exp_f32 v162, v162
    v_exp_f32 v163, v163
    v_exp_f32 v164, v164
    v_mfma_f32_32x32x16_bf16 v[144:159], a[24:27], v[208:211], v[48:63]
    s_addc_u32 s79, s57, 0
    v_exp_f32 v165, v165
    v_exp_f32 v166, v166
    v_exp_f32 v167, v167
    v_exp_f32 v168, v168
    v_exp_f32 v169, v169
    v_smfmac_f32_32x32x32_bf16 v[96:111], a[28:31], v[160:167], v4
    global_store_dwordx4 v1, v[180:183], s[90:91] sc1
    v_exp_f32 v170, v170
    v_exp_f32 v171, v171
    v_exp_f32 v172, v172
    v_exp_f32 v173, v173
    v_exp_f32 v174, v174
    v_exp_f32 v175, v175
    v_exp_f32 v144, v144
    v_exp_f32 v145, v145
    v_smfmac_f32_32x32x32_bf16 v[96:111], a[32:35], v[168:175], v4
    v_exp_f32 v146, v146
    v_exp_f32 v147, v147
    v_exp_f32 v148, v148
    v_mfma_f32_32x32x16_bf16 v[160:175], a[24:27], v[212:215], v[64:79]
    v_exp_f32 v149, v149
    v_exp_f32 v150, v150
    v_exp_f32 v151, v151
    v_exp_f32 v152, v152
    v_exp_f32 v153, v153
    v_smfmac_f32_32x32x32_bf16 v[112:127], a[28:31], v[144:151], v4
    global_load_lds_dwordx4 v5, s[78:79]
    global_load_lds_dwordx4 v7, s[78:79] offset:1024
    v_exp_f32 v154, v154
    v_exp_f32 v155, v155
    v_exp_f32 v156, v156
    v_exp_f32 v157, v157
    v_exp_f32 v158, v158
    v_exp_f32 v159, v159
    v_exp_f32 v160, v160
    v_exp_f32 v161, v161
    v_smfmac_f32_32x32x32_bf16 v[112:127], a[32:35], v[152:159], v4
    s_waitcnt vmcnt(20)
    v_exp_f32 v162, v162
    v_exp_f32 v163, v163
    v_exp_f32 v164, v164
    v_mfma_f32_32x32x16_bf16 v[144:159], a[36:39], v[200:203], v[16:31]
    v_exp_f32 v165, v165
    v_exp_f32 v166, v166
    v_exp_f32 v167, v167
    v_exp_f32 v168, v168
    v_exp_f32 v169, v169
    v_smfmac_f32_32x32x32_bf16 v[128:143], a[28:31], v[160:167], v4
    v_exp_f32 v170, v170
    v_exp_f32 v171, v171
    v_exp_f32 v172, v172
    v_exp_f32 v173, v173
    v_exp_f32 v174, v174
    v_exp_f32 v175, v175
    v_exp_f32 v144, v144
    v_exp_f32 v145, v145
    v_smfmac_f32_32x32x32_bf16 v[128:143], a[32:35], v[168:175], v4
    s_add_u32 s100, s64, s86
    global_load_dwordx4 a[24:27], v248, s[60:61] offset:0 sc1
    global_load_dwordx4 a[28:31], v3, s[60:61] offset:1024 sc1
    global_load_dwordx4 a[32:35], v3, s[60:61] offset:1536 sc1
    v_exp_f32 v146, v146
    v_exp_f32 v147, v147
    v_exp_f32 v148, v148
    v_mfma_f32_32x32x16_bf16 v[160:175], a[36:39], v[204:207], v[32:47]
    s_addc_u32 s101, s65, 0
    v_exp_f32 v149, v149
    v_exp_f32 v150, v150
    v_exp_f32 v151, v151
    v_exp_f32 v152, v152
    v_exp_f32 v153, v153
    v_smfmac_f32_32x32x32_bf16 v[80:95], a[40:43], v[144:151], v4
    s_add_u32 m0, s96, 6144
    v_exp_f32 v154, v154
    v_exp_f32 v155, v155
    v_exp_f32 v156, v156
    v_exp_f32 v157, v157
    v_exp_f32 v158, v158
    v_exp_f32 v159, v159
    v_exp_f32 v160, v160
    v_exp_f32 v161, v161
    v_smfmac_f32_32x32x32_bf16 v[80:95], a[44:47], v[152:159], v4
    s_add_u32 s78, s56, s73
    v_exp_f32 v162, v162
    v_exp_f32 v163, v163
    v_exp_f32 v164, v164
    v_mfma_f32_32x32x16_bf16 v[144:159], a[36:39], v[208:211], v[48:63]
    s_addc_u32 s79, s57, 0
    v_exp_f32 v165, v165
    v_exp_f32 v166, v166
    v_exp_f32 v167, v167
    v_exp_f32 v168, v168
    v_exp_f32 v169, v169
    v_smfmac_f32_32x32x32_bf16 v[96:111], a[40:43], v[160:167], v4
    global_store_dwordx4 v1, v[184:187], s[100:101] sc1
    v_exp_f32 v170, v170
    v_exp_f32 v171, v171
    v_exp_f32 v172, v172
    v_exp_f32 v173, v173
    v_exp_f32 v174, v174
    v_exp_f32 v175, v175
    v_exp_f32 v144, v144
    v_exp_f32 v145, v145
    v_smfmac_f32_32x32x32_bf16 v[96:111], a[44:47], v[168:175], v4
    v_exp_f32 v146, v146
    v_exp_f32 v147, v147
    v_exp_f32 v148, v148
    v_mfma_f32_32x32x16_bf16 v[160:175], a[36:39], v[212:215], v[64:79]
    v_exp_f32 v149, v149
    v_exp_f32 v150, v150
    v_exp_f32 v151, v151
    v_exp_f32 v152, v152
    v_exp_f32 v153, v153
    v_smfmac_f32_32x32x32_bf16 v[112:127], a[40:43], v[144:151], v4
    global_load_lds_dwordx4 v5, s[78:79]
    global_load_lds_dwordx4 v7, s[78:79] offset:1024
    v_exp_f32 v154, v154
    v_exp_f32 v155, v155
    v_exp_f32 v156, v156
    v_exp_f32 v157, v157
    v_exp_f32 v158, v158
    v_exp_f32 v159, v159
    v_exp_f32 v160, v160
    v_exp_f32 v161, v161
    v_smfmac_f32_32x32x32_bf16 v[112:127], a[44:47], v[152:159], v4
    s_waitcnt vmcnt(23)
    v_exp_f32 v162, v162
    v_exp_f32 v163, v163
    v_exp_f32 v164, v164
    v_mfma_f32_32x32x16_bf16 v[144:159], a[48:51], v[200:203], v[16:31]
    v_exp_f32 v165, v165
    v_exp_f32 v166, v166
    v_exp_f32 v167, v167
    v_exp_f32 v168, v168
    v_exp_f32 v169, v169
    v_smfmac_f32_32x32x32_bf16 v[128:143], a[40:43], v[160:167], v4
    v_exp_f32 v170, v170
    v_exp_f32 v171, v171
    v_exp_f32 v172, v172
    v_exp_f32 v173, v173
    v_exp_f32 v174, v174
    v_exp_f32 v175, v175
    v_exp_f32 v144, v144
    v_exp_f32 v145, v145
    v_smfmac_f32_32x32x32_bf16 v[128:143], a[44:47], v[168:175], v4
    s_add_u32 s90, s64, s87
    global_load_dwordx4 a[36:39], v248, s[60:61] offset:2048 sc1
    global_load_dwordx4 a[40:43], v3, s[60:61] offset:3072 sc1
    global_load_dwordx4 a[44:47], v3, s[60:61] offset:3584 sc1
    v_exp_f32 v146, v146
    v_exp_f32 v147, v147
    v_exp_f32 v148, v148
    v_mfma_f32_32x32x16_bf16 v[160:175], a[48:51], v[204:207], v[32:47]
    s_addc_u32 s91, s65, 0
    v_add_u32 v248, 0x2000, v248
    v_add_u32 v3, v13, v3
    v_exp_f32 v149, v149
    v_exp_f32 v150, v150
    v_exp_f32 v151, v151
    v_exp_f32 v152, v152
    v_exp_f32 v153, v153
    v_smfmac_f32_32x32x32_bf16 v[80:95], a[52:55], v[144:151], v4
    s_add_u32 m0, s96, 8192
    v_exp_f32 v154, v154
    v_exp_f32 v155, v155
    v_exp_f32 v156, v156
    v_exp_f32 v157, v157
    v_exp_f32 v158, v158
    v_exp_f32 v159, v159
    v_exp_f32 v160, v160
    v_exp_f32 v161, v161
    v_smfmac_f32_32x32x32_bf16 v[80:95], a[56:59], v[152:159], v4
    s_add_u32 s78, s56, s74
    v_exp_f32 v162, v162
    v_exp_f32 v163, v163
    v_exp_f32 v164, v164
    v_mfma_f32_32x32x16_bf16 v[144:159], a[48:51], v[208:211], v[48:63]
    s_addc_u32 s79, s57, 0
    v_exp_f32 v165, v165
    v_exp_f32 v166, v166
    v_exp_f32 v167, v167
    v_exp_f32 v168, v168
    v_exp_f32 v169, v169
    v_smfmac_f32_32x32x32_bf16 v[96:111], a[52:55], v[160:167], v4
    global_store_dwordx4 v1, v[188:191], s[90:91] sc1
    v_exp_f32 v170, v170
    v_exp_f32 v171, v171
    v_exp_f32 v172, v172
    v_exp_f32 v173, v173
    v_exp_f32 v174, v174
    v_exp_f32 v175, v175
    v_exp_f32 v144, v144
    v_exp_f32 v145, v145
    v_smfmac_f32_32x32x32_bf16 v[96:111], a[56:59], v[168:175], v4
    v_exp_f32 v146, v146
    v_exp_f32 v147, v147
    v_exp_f32 v148, v148
    v_mfma_f32_32x32x16_bf16 v[160:175], a[48:51], v[212:215], v[64:79]
    v_exp_f32 v149, v149
    v_exp_f32 v150, v150
    v_exp_f32 v151, v151
    v_exp_f32 v152, v152
    v_exp_f32 v153, v153
    v_smfmac_f32_32x32x32_bf16 v[112:127], a[52:55], v[144:151], v4
    global_load_lds_dwordx4 v5, s[78:79]
    global_load_lds_dwordx4 v7, s[78:79] offset:1024
    v_exp_f32 v154, v154
    v_exp_f32 v155, v155
    v_exp_f32 v156, v156
    v_exp_f32 v157, v157
    v_exp_f32 v158, v158
    v_exp_f32 v159, v159
    v_exp_f32 v160, v160
    v_exp_f32 v161, v161
    v_smfmac_f32_32x32x32_bf16 v[112:127], a[56:59], v[152:159], v4
    s_waitcnt vmcnt(26)
    v_exp_f32 v162, v162
    v_exp_f32 v163, v163
    v_exp_f32 v164, v164
    v_mfma_f32_32x32x16_bf16 v[144:159], a[60:63], v[200:203], v[16:31]
    v_exp_f32 v165, v165
    v_exp_f32 v166, v166
    v_exp_f32 v167, v167
    v_exp_f32 v168, v168
    v_exp_f32 v169, v169
    v_smfmac_f32_32x32x32_bf16 v[128:143], a[52:55], v[160:167], v4
    v_exp_f32 v170, v170
    v_exp_f32 v171, v171
    v_exp_f32 v172, v172
    v_exp_f32 v173, v173
    v_exp_f32 v174, v174
    v_exp_f32 v175, v175
    v_exp_f32 v144, v144
    v_exp_f32 v145, v145
    v_smfmac_f32_32x32x32_bf16 v[128:143], a[56:59], v[168:175], v4
    s_add_u32 s100, s64, s36
    global_load_dwordx4 a[48:51], v248, s[60:61] offset:-4096 sc1
    global_load_dwordx4 a[52:55], v3, s[60:61] offset:-3072 sc1
    global_load_dwordx4 a[56:59], v3, s[60:61] offset:-2560 sc1
    v_exp_f32 v146, v146
    v_exp_f32 v147, v147
    v_exp_f32 v148, v148
    v_mfma_f32_32x32x16_bf16 v[160:175], a[60:63], v[204:207], v[32:47]
    s_addc_u32 s101, s65, 0
    v_exp_f32 v149, v149
    v_exp_f32 v150, v150
    v_exp_f32 v151, v151
    v_exp_f32 v152, v152
    v_exp_f32 v153, v153
    v_smfmac_f32_32x32x32_bf16 v[80:95], a[64:67], v[144:151], v4
    s_add_u32 m0, s96, 10240
    v_exp_f32 v154, v154
    v_exp_f32 v155, v155
    v_exp_f32 v156, v156
    v_exp_f32 v157, v157
    v_exp_f32 v158, v158
    v_exp_f32 v159, v159
    v_exp_f32 v160, v160
    v_exp_f32 v161, v161
    v_smfmac_f32_32x32x32_bf16 v[80:95], a[68:71], v[152:159], v4
    s_add_u32 s78, s56, s75
    v_exp_f32 v162, v162
    v_exp_f32 v163, v163
    v_exp_f32 v164, v164
    v_mfma_f32_32x32x16_bf16 v[144:159], a[60:63], v[208:211], v[48:63]
    s_addc_u32 s79, s57, 0
    v_exp_f32 v165, v165
    v_exp_f32 v166, v166
    v_exp_f32 v167, v167
    v_exp_f32 v168, v168
    v_exp_f32 v169, v169
    v_smfmac_f32_32x32x32_bf16 v[96:111], a[64:67], v[160:167], v4
    global_store_dwordx4 v1, v[192:195], s[100:101] sc1
    v_exp_f32 v170, v170
    v_exp_f32 v171, v171
    v_exp_f32 v172, v172
    v_exp_f32 v173, v173
    v_exp_f32 v174, v174
    v_exp_f32 v175, v175
    v_exp_f32 v144, v144
    v_exp_f32 v145, v145
    v_smfmac_f32_32x32x32_bf16 v[96:111], a[68:71], v[168:175], v4
    v_exp_f32 v146, v146
    v_exp_f32 v147, v147
    v_exp_f32 v148, v148
    v_mfma_f32_32x32x16_bf16 v[160:175], a[60:63], v[212:215], v[64:79]
    v_exp_f32 v149, v149
    v_exp_f32 v150, v150
    v_exp_f32 v151, v151
    v_exp_f32 v152, v152
    v_exp_f32 v153, v153
    v_smfmac_f32_32x32x32_bf16 v[112:127], a[64:67], v[144:151], v4
    global_load_lds_dwordx4 v5, s[78:79]
    global_load_lds_dwordx4 v7, s[78:79] offset:1024
    v_exp_f32 v154, v154
    v_exp_f32 v155, v155
    v_exp_f32 v156, v156
    v_exp_f32 v157, v157
    v_exp_f32 v158, v158
    v_exp_f32 v159, v159
    v_exp_f32 v160, v160
    v_exp_f32 v161, v161
    v_smfmac_f32_32x32x32_bf16 v[112:127], a[68:71], v[152:159], v4
    s_waitcnt vmcnt(27)
    v_exp_f32 v162, v162
    v_exp_f32 v163, v163
    v_exp_f32 v164, v164
    v_mfma_f32_32x32x16_bf16 v[144:159], a[0:3], v[200:203], v[16:31]
    v_exp_f32 v165, v165
    v_exp_f32 v166, v166
    v_exp_f32 v167, v167
    v_exp_f32 v168, v168
    v_exp_f32 v169, v169
    v_smfmac_f32_32x32x32_bf16 v[128:143], a[64:67], v[160:167], v4
    v_exp_f32 v170, v170
    v_exp_f32 v171, v171
    v_exp_f32 v172, v172
    v_exp_f32 v173, v173
    v_exp_f32 v174, v174
    v_exp_f32 v175, v175
    v_exp_f32 v144, v144
    v_exp_f32 v145, v145
    v_smfmac_f32_32x32x32_bf16 v[128:143], a[68:71], v[168:175], v4
    s_add_u32 s90, s64, s37
    global_load_dwordx4 a[60:63], v248, s[60:61] offset:-2048 sc1
    global_load_dwordx4 a[64:67], v3, s[60:61] offset:-1024 sc1
    global_load_dwordx4 a[68:71], v3, s[60:61] offset:-512 sc1
    v_exp_f32 v146, v146
    v_exp_f32 v147, v147
    v_exp_f32 v148, v148
    v_mfma_f32_32x32x16_bf16 v[160:175], a[0:3], v[204:207], v[32:47]
    s_addc_u32 s91, s65, 0
    v_exp_f32 v149, v149
    v_exp_f32 v150, v150
    v_exp_f32 v151, v151
    v_exp_f32 v152, v152
    v_exp_f32 v153, v153
    v_smfmac_f32_32x32x32_bf16 v[80:95], a[4:7], v[144:151], v4
    s_add_u32 m0, s96, 12288
    v_exp_f32 v154, v154
    v_exp_f32 v155, v155
    v_exp_f32 v156, v156
    v_exp_f32 v157, v157
    v_exp_f32 v158, v158
    v_exp_f32 v159, v159
    v_exp_f32 v160, v160
    v_exp_f32 v161, v161
    v_smfmac_f32_32x32x32_bf16 v[80:95], a[8:11], v[152:159], v4
    s_add_u32 s78, s56, s76
    v_exp_f32 v162, v162
    v_exp_f32 v163, v163
    v_exp_f32 v164, v164
    v_mfma_f32_32x32x16_bf16 v[144:159], a[0:3], v[208:211], v[48:63]
    s_addc_u32 s79, s57, 0
    v_exp_f32 v165, v165
    v_exp_f32 v166, v166
    v_exp_f32 v167, v167
    v_exp_f32 v168, v168
    v_exp_f32 v169, v169
    v_smfmac_f32_32x32x32_bf16 v[96:111], a[4:7], v[160:167], v4
    global_store_dwordx4 v1, v[196:199], s[90:91] sc1
    v_exp_f32 v170, v170
    v_exp_f32 v171, v171
    v_exp_f32 v172, v172
    v_exp_f32 v173, v173
    v_exp_f32 v174, v174
    v_exp_f32 v175, v175
    v_exp_f32 v144, v144
    v_exp_f32 v145, v145
    v_smfmac_f32_32x32x32_bf16 v[96:111], a[8:11], v[168:175], v4
    v_exp_f32 v146, v146
    v_exp_f32 v147, v147
    v_exp_f32 v148, v148
    v_mfma_f32_32x32x16_bf16 v[160:175], a[0:3], v[212:215], v[64:79]
    v_exp_f32 v149, v149
    v_exp_f32 v150, v150
    v_exp_f32 v151, v151
    v_exp_f32 v152, v152
    v_exp_f32 v153, v153
    v_smfmac_f32_32x32x32_bf16 v[112:127], a[4:7], v[144:151], v4
    global_load_lds_dwordx4 v5, s[78:79]
    global_load_lds_dwordx4 v7, s[78:79] offset:1024
    v_exp_f32 v154, v154
    v_exp_f32 v155, v155
    v_exp_f32 v156, v156
    v_exp_f32 v157, v157
    v_exp_f32 v158, v158
    v_exp_f32 v159, v159
    v_exp_f32 v160, v160
    v_exp_f32 v161, v161
    v_smfmac_f32_32x32x32_bf16 v[112:127], a[8:11], v[152:159], v4
    s_waitcnt vmcnt(27)
    v_exp_f32 v162, v162
    v_exp_f32 v163, v163
    v_exp_f32 v164, v164
    v_mfma_f32_32x32x16_bf16 v[144:159], a[12:15], v[200:203], v[16:31]
    v_exp_f32 v165, v165
    v_exp_f32 v166, v166
    v_exp_f32 v167, v167
    v_exp_f32 v168, v168
    v_exp_f32 v169, v169
    v_smfmac_f32_32x32x32_bf16 v[128:143], a[4:7], v[160:167], v4
    v_exp_f32 v170, v170
    v_exp_f32 v171, v171
    v_exp_f32 v172, v172
    v_exp_f32 v173, v173
    v_exp_f32 v174, v174
    v_exp_f32 v175, v175
    v_exp_f32 v144, v144
    v_exp_f32 v145, v145
    v_smfmac_f32_32x32x32_bf16 v[128:143], a[8:11], v[168:175], v4
    s_add_u32 s100, s60, s7
    global_load_dwordx4 a[0:3], v248, s[60:61] offset:0 sc1
    global_load_dwordx4 a[4:7], v3, s[60:61] offset:1024 sc1
    global_load_dwordx4 a[8:11], v3, s[60:61] offset:1536 sc1
    v_exp_f32 v146, v146
    v_exp_f32 v147, v147
    v_exp_f32 v148, v148
    v_mfma_f32_32x32x16_bf16 v[160:175], a[12:15], v[204:207], v[32:47]
    s_addc_u32 s101, s61, 0
    v_exp_f32 v149, v149
    v_exp_f32 v150, v150
    v_exp_f32 v151, v151
    v_exp_f32 v152, v152
    v_exp_f32 v153, v153
    v_smfmac_f32_32x32x32_bf16 v[80:95], a[16:19], v[144:151], v4
    s_add_u32 m0, s96, 14336
    v_exp_f32 v154, v154
    v_exp_f32 v155, v155
    v_exp_f32 v156, v156
    v_exp_f32 v157, v157
    v_exp_f32 v158, v158
    v_exp_f32 v159, v159
    v_exp_f32 v160, v160
    v_exp_f32 v161, v161
    v_smfmac_f32_32x32x32_bf16 v[80:95], a[20:23], v[152:159], v4
    s_add_u32 s78, s56, s77
    v_exp_f32 v162, v162
    v_exp_f32 v163, v163
    v_exp_f32 v164, v164
    v_mfma_f32_32x32x16_bf16 v[144:159], a[12:15], v[208:211], v[48:63]
    s_addc_u32 s79, s57, 0
    v_exp_f32 v165, v165
    v_exp_f32 v166, v166
    v_exp_f32 v167, v167
    v_exp_f32 v168, v168
    v_exp_f32 v169, v169
    v_smfmac_f32_32x32x32_bf16 v[96:111], a[16:19], v[160:167], v4
    global_store_dwordx4 v1, v[216:219], s[100:101] sc1
    v_exp_f32 v170, v170
    v_exp_f32 v171, v171
    v_exp_f32 v172, v172
    v_exp_f32 v173, v173
    v_exp_f32 v174, v174
    v_exp_f32 v175, v175
    v_exp_f32 v144, v144
    v_exp_f32 v145, v145
    v_smfmac_f32_32x32x32_bf16 v[96:111], a[20:23], v[168:175], v4
    s_add_u32 s7, s7, 524288
    v_exp_f32 v146, v146
    v_exp_f32 v147, v147
    v_exp_f32 v148, v148
    v_mfma_f32_32x32x16_bf16 v[160:175], a[12:15], v[212:215], v[64:79]
    v_exp_f32 v149, v149
    v_exp_f32 v150, v150
    v_exp_f32 v151, v151
    v_exp_f32 v152, v152
    v_exp_f32 v153, v153
    v_smfmac_f32_32x32x32_bf16 v[112:127], a[16:19], v[144:151], v4
    global_load_lds_dwordx4 v5, s[78:79]
    global_load_lds_dwordx4 v7, s[78:79] offset:1024
    v_exp_f32 v154, v154
    v_exp_f32 v155, v155
    v_exp_f32 v156, v156
    v_exp_f32 v157, v157
    v_exp_f32 v158, v158
    v_exp_f32 v159, v159
    v_exp_f32 v160, v160
    v_exp_f32 v161, v161
    v_smfmac_f32_32x32x32_bf16 v[112:127], a[20:23], v[152:159], v4
    s_waitcnt vmcnt(27)
    v_exp_f32 v162, v162
    v_exp_f32 v163, v163
    v_exp_f32 v164, v164
    v_mfma_f32_32x32x16_bf16 v[144:159], a[24:27], v[200:203], v[16:31]
    v_exp_f32 v165, v165
    v_exp_f32 v166, v166
    v_exp_f32 v167, v167
    v_exp_f32 v168, v168
    v_exp_f32 v169, v169
    v_smfmac_f32_32x32x32_bf16 v[128:143], a[16:19], v[160:167], v4
L_pad6:
    s_cbranch_execz L_pad10
    v_exp_f32 v170, v170
    v_exp_f32 v171, v171
    v_exp_f32 v172, v172
    v_exp_f32 v173, v173
    v_exp_f32 v174, v174
    v_exp_f32 v175, v175
    v_exp_f32 v144, v144
    v_exp_f32 v145, v145
    v_smfmac_f32_32x32x32_bf16 v[128:143], a[20:23], v[168:175], v4
    s_add_u32 s90, s60, s7
    global_load_dwordx4 a[12:15], v248, s[60:61] offset:2048 sc1
    global_load_dwordx4 a[16:19], v3, s[60:61] offset:3072 sc1
    global_load_dwordx4 a[20:23], v3, s[60:61] offset:3584 sc1
    v_exp_f32 v146, v146
    v_exp_f32 v147, v147
    v_exp_f32 v148, v148
    v_mfma_f32_32x32x16_bf16 v[160:175], a[24:27], v[204:207], v[32:47]
    s_addc_u32 s91, s61, 0
    v_add_u32 v248, 0x2000, v248
    v_add_u32 v3, v13, v3
    v_exp_f32 v149, v149
    v_exp_f32 v150, v150
    v_exp_f32 v151, v151
    v_exp_f32 v152, v152
    v_exp_f32 v153, v153
    v_smfmac_f32_32x32x32_bf16 v[80:95], a[28:31], v[144:151], v4
    s_add_u32 m0, s96, 16384
    v_exp_f32 v154, v154
    v_exp_f32 v155, v155
    v_exp_f32 v156, v156
    v_exp_f32 v157, v157
    v_exp_f32 v158, v158
    v_exp_f32 v159, v159
    v_exp_f32 v160, v160
    v_exp_f32 v161, v161
    v_smfmac_f32_32x32x32_bf16 v[80:95], a[32:35], v[152:159], v4
    s_add_u32 s78, s52, s38
    v_exp_f32 v162, v162
    v_exp_f32 v163, v163
    v_exp_f32 v164, v164
    v_mfma_f32_32x32x16_bf16 v[144:159], a[24:27], v[208:211], v[48:63]
    s_addc_u32 s79, s53, 0
    v_exp_f32 v165, v165
    v_exp_f32 v166, v166
    v_exp_f32 v167, v167
    v_exp_f32 v168, v168
    v_exp_f32 v169, v169
    v_smfmac_f32_32x32x32_bf16 v[96:111], a[28:31], v[160:167], v4
    global_store_dwordx4 v1, v[216:219], s[90:91] sc1
    v_exp_f32 v170, v170
    v_exp_f32 v171, v171
    v_exp_f32 v172, v172
    v_exp_f32 v173, v173
    v_exp_f32 v174, v174
    v_exp_f32 v175, v175
    v_exp_f32 v144, v144
    v_exp_f32 v145, v145
    v_smfmac_f32_32x32x32_bf16 v[96:111], a[32:35], v[168:175], v4
    v_exp_f32 v146, v146
    v_exp_f32 v147, v147
    v_exp_f32 v148, v148
    v_mfma_f32_32x32x16_bf16 v[160:175], a[24:27], v[212:215], v[64:79]
    v_exp_f32 v149, v149
    v_exp_f32 v150, v150
    v_exp_f32 v151, v151
    v_exp_f32 v152, v152
    v_exp_f32 v153, v153
    v_smfmac_f32_32x32x32_bf16 v[112:127], a[28:31], v[144:151], v4
    global_load_lds_dwordx4 v5, s[78:79]
    global_load_lds_dwordx4 v7, s[78:79] offset:1024
    v_exp_f32 v154, v154
    v_exp_f32 v155, v155
    v_exp_f32 v156, v156
    v_exp_f32 v157, v157
    v_exp_f32 v158, v158
    v_exp_f32 v159, v159
    v_exp_f32 v160, v160
    v_exp_f32 v161, v161
    v_smfmac_f32_32x32x32_bf16 v[112:127], a[32:35], v[152:159], v4
    s_waitcnt vmcnt(27)
    v_exp_f32 v162, v162
    v_exp_f32 v163, v163
    v_exp_f32 v164, v164
    v_mfma_f32_32x32x16_bf16 v[144:159], a[36:39], v[200:203], v[16:31]
    v_exp_f32 v165, v165
    v_exp_f32 v166, v166
    v_exp_f32 v167, v167
    v_exp_f32 v168, v168
    v_exp_f32 v169, v169
    v_smfmac_f32_32x32x32_bf16 v[128:143], a[28:31], v[160:167], v4
    v_exp_f32 v170, v170
    v_exp_f32 v171, v171
    v_exp_f32 v172, v172
    v_exp_f32 v173, v173
    v_exp_f32 v174, v174
    v_exp_f32 v175, v175
    v_exp_f32 v144, v144
    v_exp_f32 v145, v145
    v_smfmac_f32_32x32x32_bf16 v[128:143], a[32:35], v[168:175], v4
    s_add_u32 m0, s96, 18432
    global_load_dwordx4 a[24:27], v248, s[60:61] offset:-4096 sc1
    global_load_dwordx4 a[28:31], v3, s[60:61] offset:-3072 sc1
    global_load_dwordx4 a[32:35], v3, s[60:61] offset:-2560 sc1
    v_exp_f32 v146, v146
    v_exp_f32 v147, v147
    v_exp_f32 v148, v148
    v_mfma_f32_32x32x16_bf16 v[160:175], a[36:39], v[204:207], v[32:47]
    s_add_u32 s78, s52, s39
    v_exp_f32 v149, v149
    v_exp_f32 v150, v150
    v_exp_f32 v151, v151
    v_exp_f32 v152, v152
    v_exp_f32 v153, v153
    v_smfmac_f32_32x32x32_bf16 v[80:95], a[40:43], v[144:151], v4
    s_addc_u32 s79, s53, 0
    v_exp_f32 v154, v154
    v_exp_f32 v155, v155
    v_exp_f32 v156, v156
    v_exp_f32 v157, v157
    v_exp_f32 v158, v158
    v_exp_f32 v159, v159
    v_exp_f32 v160, v160
    v_exp_f32 v161, v161
    v_smfmac_f32_32x32x32_bf16 v[80:95], a[44:47], v[152:159], v4
    v_exp_f32 v162, v162
    v_exp_f32 v163, v163
    v_exp_f32 v164, v164
    v_mfma_f32_32x32x16_bf16 v[144:159], a[36:39], v[208:211], v[48:63]
    v_exp_f32 v165, v165
    v_exp_f32 v166, v166
    v_exp_f32 v167, v167
    v_exp_f32 v168, v168
    v_exp_f32 v169, v169
    v_smfmac_f32_32x32x32_bf16 v[96:111], a[40:43], v[160:167], v4
    global_load_lds_dwordx4 v5, s[78:79]
    global_load_lds_dwordx4 v7, s[78:79] offset:1024
    v_exp_f32 v170, v170
    v_exp_f32 v171, v171
    v_exp_f32 v172, v172
    v_exp_f32 v173, v173
    v_exp_f32 v174, v174
    v_exp_f32 v175, v175
    v_exp_f32 v144, v144
    v_exp_f32 v145, v145
    v_smfmac_f32_32x32x32_bf16 v[96:111], a[44:47], v[168:175], v4
    v_exp_f32 v146, v146
    v_exp_f32 v147, v147
    v_exp_f32 v148, v148
    v_mfma_f32_32x32x16_bf16 v[160:175], a[36:39], v[212:215], v[64:79]
    v_exp_f32 v149, v149
    v_exp_f32 v150, v150
    v_exp_f32 v151, v151
    v_exp_f32 v152, v152
    v_exp_f32 v153, v153
    v_smfmac_f32_32x32x32_bf16 v[112:127], a[40:43], v[144:151], v4
    v_exp_f32 v154, v154
    v_exp_f32 v155, v155
    v_exp_f32 v156, v156
    v_exp_f32 v157, v157
    v_exp_f32 v158, v158
    v_exp_f32 v159, v159
    v_exp_f32 v160, v160
    v_exp_f32 v161, v161
    v_smfmac_f32_32x32x32_bf16 v[112:127], a[44:47], v[152:159], v4
    s_waitcnt vmcnt(26)
    v_exp_f32 v162, v162
    v_exp_f32 v163, v163
    v_exp_f32 v164, v164
    v_mfma_f32_32x32x16_bf16 v[144:159], a[48:51], v[200:203], v[16:31]
    v_exp_f32 v165, v165
    v_exp_f32 v166, v166
    v_exp_f32 v167, v167
    v_exp_f32 v168, v168
    v_exp_f32 v169, v169
    v_smfmac_f32_32x32x32_bf16 v[128:143], a[40:43], v[160:167], v4
    v_exp_f32 v170, v170
    v_exp_f32 v171, v171
    v_exp_f32 v172, v172
    v_exp_f32 v173, v173
    v_exp_f32 v174, v174
    v_exp_f32 v175, v175
    v_exp_f32 v144, v144
    v_exp_f32_e64 v145, v145
    v_smfmac_f32_32x32x32_bf16 v[128:143], a[44:47], v[168:175], v4
    s_add_u32 m0, s96, 20480
    global_load_dwordx4 a[36:39], v248, s[60:61] offset:-2048 sc1
    global_load_dwordx4 a[40:43], v3, s[60:61] offset:-1024 sc1
    global_load_dwordx4 a[44:47], v3, s[60:61] offset:-512 sc1
    v_exp_f32 v146, v146
    v_exp_f32 v147, v147
    v_exp_f32 v148, v148
    v_mfma_f32_32x32x16_bf16 v[160:175], a[48:51], v[204:207], v[32:47]
    s_add_u32 s78, s52, s22
    v_exp_f32 v149, v149
    v_exp_f32 v150, v150
    v_exp_f32 v151, v151
    v_exp_f32 v152, v152
    v_exp_f32 v153, v153
    v_smfmac_f32_32x32x32_bf16 v[80:95], a[52:55], v[144:151], v4
    s_addc_u32 s79, s53, 0
    v_exp_f32 v154, v154
    v_exp_f32 v155, v155
    v_exp_f32 v156, v156
    v_exp_f32 v157, v157
    v_exp_f32 v158, v158
    v_exp_f32 v159, v159
    v_exp_f32 v160, v160
    v_exp_f32_e64 v161, v161
    v_smfmac_f32_32x32x32_bf16 v[80:95], a[56:59], v[152:159], v4
    s_waitcnt vmcnt(14)
    ds_read_b64_tr_b16 v[176:177], v9 offset:0
    ds_read_b64_tr_b16 v[178:179], v9 offset:1024
    ds_read_b64_tr_b16 v[180:181], v10 offset:0
    ds_read_b64_tr_b16 v[182:183], v10 offset:1024
    v_exp_f32 v162, v162
    v_exp_f32 v163, v163
    v_exp_f32_e64 v164, v164
    v_mfma_f32_32x32x16_bf16 v[144:159], a[48:51], v[208:211], v[48:63]
    ds_read_b64_tr_b16 v[184:185], v9 offset:2048
    ds_read_b64_tr_b16 v[186:187], v9 offset:3072
    ds_read_b64_tr_b16 v[188:189], v10 offset:2048
    ds_read_b64_tr_b16 v[190:191], v10 offset:3072
    v_exp_f32 v165, v165
    v_exp_f32 v166, v166
    v_exp_f32 v167, v167
    v_exp_f32 v168, v168
    v_exp_f32 v169, v169
    v_smfmac_f32_32x32x32_bf16 v[96:111], a[52:55], v[160:167], v4
    global_load_lds_dwordx4 v5, s[78:79]
    global_load_lds_dwordx4 v7, s[78:79] offset:1024
    v_exp_f32 v170, v170
    v_exp_f32 v171, v171
    v_exp_f32 v172, v172
    v_exp_f32 v173, v173
    v_exp_f32 v174, v174
    v_exp_f32 v175, v175
    v_exp_f32 v144, v144
    v_exp_f32_e64 v145, v145
    v_smfmac_f32_32x32x32_bf16 v[96:111], a[56:59], v[168:175], v4
    s_add_u32 m0, s96, 22528
    ds_read_b64_tr_b16 v[192:193], v9 offset:4096
    ds_read_b64_tr_b16 v[194:195], v9 offset:5120
    ds_read_b64_tr_b16 v[196:197], v10 offset:4096
    ds_read_b64_tr_b16 v[198:199], v10 offset:5120
    v_exp_f32 v146, v146
    v_exp_f32 v147, v147
    v_exp_f32_e64 v148, v148
    v_mfma_f32_32x32x16_bf16 v[160:175], a[48:51], v[212:215], v[64:79]
    ds_read_b64_tr_b16 v[216:217], v9 offset:6144
    ds_read_b64_tr_b16 v[218:219], v9 offset:7168
    ds_read_b64_tr_b16 v[220:221], v10 offset:6144
    ds_read_b64_tr_b16 v[222:223], v10 offset:7168
    v_exp_f32 v149, v149
    v_exp_f32 v150, v150
    v_exp_f32 v151, v151
    v_exp_f32 v152, v152
    v_exp_f32 v153, v153
    v_smfmac_f32_32x32x32_bf16 v[112:127], a[52:55], v[144:151], v4
    buffer_load_dwordx4 v5, s[52:55], s23 offen lds
    buffer_load_dwordx4 v7, s[52:55], s23 offen offset:1024 lds
    v_exp_f32 v154, v154
    v_exp_f32 v155, v155
    v_exp_f32 v156, v156
    v_exp_f32 v157, v157
    v_exp_f32 v158, v158
    v_exp_f32 v159, v159
    v_exp_f32 v160, v160
    v_exp_f32_e64 v161, v161
    v_smfmac_f32_32x32x32_bf16 v[112:127], a[56:59], v[152:159], v4
    ds_read_b64_tr_b16 v[224:225], v9 offset:8192
    ds_read_b64_tr_b16 v[226:227], v9 offset:9216
    ds_read_b64_tr_b16 v[228:229], v10 offset:8192
    ds_read_b64_tr_b16 v[230:231], v10 offset:9216
    v_exp_f32 v162, v162
    v_exp_f32 v163, v163
    v_exp_f32_e64 v164, v164
    v_mfma_f32_32x32x16_bf16 v[144:159], a[60:63], v[200:203], v[16:31]
    ds_read_b64_tr_b16 v[232:233], v9 offset:10240
    ds_read_b64_tr_b16 v[234:235], v9 offset:11264
    ds_read_b64_tr_b16 v[236:237], v10 offset:10240
    ds_read_b64_tr_b16 v[238:239], v10 offset:11264
    v_exp_f32 v165, v165
    v_exp_f32 v166, v166
    v_exp_f32 v167, v167
    v_exp_f32 v168, v168
    v_exp_f32_e64 v169, v169
    v_smfmac_f32_32x32x32_bf16 v[128:143], a[52:55], v[160:167], v4
    ds_read_b64_tr_b16 v[240:241], v9 offset:12288
    ds_read_b64_tr_b16 v[242:243], v9 offset:13312
    ds_read_b64_tr_b16 v[244:245], v10 offset:12288
    ds_read_b64_tr_b16 v[246:247], v10 offset:13312
    v_exp_f32 v170, v170
    v_exp_f32 v171, v171
    v_exp_f32 v172, v172
    v_exp_f32 v173, v173
    v_exp_f32 v174, v174
    v_exp_f32 v175, v175
    v_exp_f32 v144, v144
    v_exp_f32 v145, v145
    v_smfmac_f32_32x32x32_bf16 v[128:143], a[56:59], v[168:175], v4
    s_add_u32 m0, s96, 24576
    global_load_dwordx4 a[48:51], v248, s[60:61] offset:0 sc1
    global_load_dwordx4 a[52:55], v3, s[60:61] offset:1024 sc1
    global_load_dwordx4 a[56:59], v3, s[60:61] offset:1536 sc1
    v_exp_f32 v146, v146
    v_exp_f32 v147, v147
    v_exp_f32 v148, v148
    v_mfma_f32_32x32x16_bf16 v[160:175], a[60:63], v[204:207], v[32:47]
    s_add_u32 s78, s52, s24
    ds_read_b64_tr_b16 a[248:249], v9 offset:14336
    ds_read_b64_tr_b16 a[250:251], v9 offset:15360
    ds_read_b64_tr_b16 a[252:253], v10 offset:14336
    ds_read_b64_tr_b16 a[254:255], v10 offset:15360
    v_exp_f32 v149, v149
    v_exp_f32 v150, v150
    v_exp_f32 v151, v151
    v_exp_f32 v152, v152
    v_exp_f32 v153, v153
    v_smfmac_f32_32x32x32_bf16 v[80:95], a[64:67], v[144:151], v4
    s_addc_u32 s79, s53, 0
    v_exp_f32 v154, v154
    v_exp_f32 v155, v155
    v_exp_f32 v156, v156
    v_exp_f32 v157, v157
    v_exp_f32 v158, v158
    v_exp_f32 v159, v159
    v_exp_f32 v160, v160
    v_exp_f32 v161, v161
    v_smfmac_f32_32x32x32_bf16 v[80:95], a[68:71], v[152:159], v4
    v_exp_f32 v162, v162
    v_exp_f32 v163, v163
    v_exp_f32 v164, v164
    v_mfma_f32_32x32x16_bf16 v[144:159], a[60:63], v[208:211], v[48:63]
    v_exp_f32 v165, v165
    v_exp_f32 v166, v166
    v_exp_f32 v167, v167
    v_exp_f32 v168, v168
    v_exp_f32 v169, v169
    v_smfmac_f32_32x32x32_bf16 v[96:111], a[64:67], v[160:167], v4
    global_load_lds_dwordx4 v5, s[78:79]
    global_load_lds_dwordx4 v7, s[78:79] offset:1024
    v_exp_f32 v170, v170
    v_exp_f32 v171, v171
    v_exp_f32 v172, v172
    v_exp_f32 v173, v173
    v_exp_f32 v174, v174
    v_exp_f32 v175, v175
    v_exp_f32 v144, v144
    v_exp_f32 v145, v145
    v_smfmac_f32_32x32x32_bf16 v[96:111], a[68:71], v[168:175], v4
    s_waitcnt vmcnt(19)
    v_lshlrev_b32 v252, 23, v0
    v_exp_f32 v146, v146
    v_exp_f32 v147, v147
    v_exp_f32 v148, v148
    v_mfma_f32_32x32x16_bf16 v[160:175], a[60:63], v[212:215], v[64:79]
    s_add_u32 m0, s96, 26624
    v_exp_f32 v149, v149
    v_exp_f32 v150, v150
    v_exp_f32 v151, v151
    v_exp_f32 v152, v152
    v_exp_f32 v153, v153
    v_smfmac_f32_32x32x32_bf16 v[112:127], a[64:67], v[144:151], v4
    buffer_store_dword v249, v252, s[60:63], s95 offen sc1
    v_exp_f32 v154, v154
    v_exp_f32 v155, v155
    v_exp_f32 v156, v156
    v_exp_f32 v157, v157
    v_exp_f32 v158, v158
    v_exp_f32 v159, v159
    v_exp_f32 v160, v160
    v_exp_f32 v161, v161
    v_smfmac_f32_32x32x32_bf16 v[112:127], a[68:71], v[152:159], v4
    v_exp_f32 v162, v162
    v_exp_f32 v163, v163
    v_exp_f32 v164, v164
    v_mfma_f32_32x32x16_bf16 v[144:159], a[0:3], v[200:203], v[16:31]
    s_add_u32 s78, s52, s25
    v_exp_f32 v165, v165
    v_exp_f32 v166, v166
    v_exp_f32 v167, v167
    v_exp_f32 v168, v168
    v_exp_f32 v169, v169
    v_smfmac_f32_32x32x32_bf16 v[128:143], a[64:67], v[160:167], v4
    s_addc_u32 s79, s53, 0
    v_exp_f32 v170, v170
    v_exp_f32 v171, v171
    v_exp_f32 v172, v172
    v_exp_f32 v173, v173
    v_exp_f32 v174, v174
    v_exp_f32 v175, v175
    v_exp_f32 v144, v144
    v_exp_f32 v145, v145
    v_smfmac_f32_32x32x32_bf16 v[128:143], a[68:71], v[168:175], v4
    global_load_dwordx4 a[60:63], v248, s[60:61] offset:2048 sc1
    global_load_dwordx4 a[64:67], v3, s[60:61] offset:3072 sc1
    global_load_dwordx4 a[68:71], v3, s[60:61] offset:3584 sc1
    v_exp_f32 v146, v146
    v_exp_f32 v147, v147
    v_exp_f32 v148, v148
    v_mfma_f32_32x32x16_bf16 v[160:175], a[0:3], v[204:207], v[32:47]
    v_add_u32 v248, 0x2000, v248
    v_add_u32 v3, v13, v3
    v_exp_f32 v149, v149
    v_exp_f32 v150, v150
    v_exp_f32 v151, v151
    v_exp_f32 v152, v152
    v_exp_f32 v153, v153
    v_smfmac_f32_32x32x32_bf16 v[80:95], a[4:7], v[144:151], v4
    v_exp_f32 v154, v154
    v_exp_f32 v155, v155
    v_exp_f32 v156, v156
    v_exp_f32 v157, v157
    v_exp_f32 v158, v158
    v_exp_f32 v159, v159
    v_exp_f32 v160, v160
    v_exp_f32 v161, v161
    v_smfmac_f32_32x32x32_bf16 v[80:95], a[8:11], v[152:159], v4
    v_exp_f32 v162, v162
    v_exp_f32 v163, v163
    v_exp_f32 v164, v164
    v_mfma_f32_32x32x16_bf16 v[144:159], a[0:3], v[208:211], v[48:63]
    v_exp_f32 v165, v165
    v_exp_f32 v166, v166
    v_exp_f32 v167, v167
    v_exp_f32 v168, v168
    v_exp_f32 v169, v169
    v_smfmac_f32_32x32x32_bf16 v[96:111], a[4:7], v[160:167], v4
    global_load_lds_dwordx4 v5, s[78:79]
    global_load_lds_dwordx4 v7, s[78:79] offset:1024
    v_exp_f32 v170, v170
    v_exp_f32 v171, v171
    v_exp_f32 v172, v172
    v_exp_f32 v173, v173
    v_exp_f32 v174, v174
    v_exp_f32 v175, v175
    v_exp_f32 v144, v144
    v_exp_f32 v145, v145
    v_smfmac_f32_32x32x32_bf16 v[96:111], a[8:11], v[168:175], v4
    s_add_u32 m0, s96, 28672
    v_exp_f32 v146, v146
    v_exp_f32 v147, v147
    v_exp_f32 v148, v148
    v_mfma_f32_32x32x16_bf16 v[160:175], a[0:3], v[212:215], v[64:79]
    s_add_u32 s78, s52, s26
    v_exp_f32 v149, v149
    v_exp_f32 v150, v150
    v_exp_f32 v151, v151
    v_exp_f32 v152, v152
    v_exp_f32 v153, v153
    v_smfmac_f32_32x32x32_bf16 v[112:127], a[4:7], v[144:151], v4
    s_addc_u32 s79, s53, 0
    global_load_lds_dwordx4 v5, s[78:79]
    global_load_lds_dwordx4 v7, s[78:79] offset:1024
    v_exp_f32 v154, v154
    v_exp_f32 v155, v155
    v_exp_f32 v156, v156
    v_exp_f32 v157, v157
    v_exp_f32 v158, v158
    v_exp_f32 v159, v159
    v_exp_f32 v160, v160
    v_exp_f32 v161, v161
    v_smfmac_f32_32x32x32_bf16 v[112:127], a[8:11], v[152:159], v4
    v_exp_f32 v162, v162
    v_exp_f32 v163, v163
    v_exp_f32 v164, v164
    v_mfma_f32_32x32x16_bf16 v[144:159], a[12:15], v[200:203], v[16:31]
    s_add_u32 m0, s96, 30720
    v_exp_f32 v165, v165
    v_exp_f32 v166, v166
    v_exp_f32 v167, v167
    v_exp_f32 v168, v168
    v_exp_f32 v169, v169
    v_smfmac_f32_32x32x32_bf16 v[128:143], a[4:7], v[160:167], v4
    s_add_u32 s78, s52, s27
    v_exp_f32 v170, v170
    v_exp_f32 v171, v171
    v_exp_f32 v172, v172
    v_exp_f32 v173, v173
    v_exp_f32 v174, v174
    v_exp_f32 v175, v175
    v_exp_f32 v144, v144
    v_exp_f32 v145, v145
    v_smfmac_f32_32x32x32_bf16 v[128:143], a[8:11], v[168:175], v4
    s_addc_u32 s79, s53, 0
    global_load_dwordx4 a[0:3], v248, s[60:61] offset:-4096 sc1
    global_load_dwordx4 a[4:7], v3, s[60:61] offset:-3072 sc1
    global_load_dwordx4 a[8:11], v3, s[60:61] offset:-2560 sc1
    v_exp_f32 v146, v146
    v_exp_f32 v147, v147
    v_exp_f32 v148, v148
    v_mfma_f32_32x32x16_bf16 v[160:175], a[12:15], v[204:207], v[32:47]
    v_exp_f32 v149, v149
    v_exp_f32 v150, v150
    v_exp_f32 v151, v151
    v_exp_f32 v152, v152
    v_exp_f32 v153, v153
    v_smfmac_f32_32x32x32_bf16 v[80:95], a[16:19], v[144:151], v4
    v_exp_f32 v154, v154
    v_exp_f32 v155, v155
    v_exp_f32 v156, v156
    v_exp_f32 v157, v157
    v_exp_f32 v158, v158
    v_exp_f32 v159, v159
    v_exp_f32 v160, v160
    v_exp_f32 v161, v161
    v_smfmac_f32_32x32x32_bf16 v[80:95], a[20:23], v[152:159], v4
    v_exp_f32 v162, v162
    v_exp_f32 v163, v163
    v_exp_f32 v164, v164
    v_mfma_f32_32x32x16_bf16 v[144:159], a[12:15], v[208:211], v[48:63]
    v_exp_f32 v165, v165
    v_exp_f32 v166, v166
    v_exp_f32 v167, v167
    v_exp_f32 v168, v168
    v_exp_f32 v169, v169
    v_smfmac_f32_32x32x32_bf16 v[96:111], a[16:19], v[160:167], v4
    global_load_lds_dwordx4 v5, s[78:79]
    global_load_lds_dwordx4 v7, s[78:79] offset:1024
    v_exp_f32 v170, v170
    v_exp_f32 v171, v171
    v_exp_f32 v172, v172
    v_exp_f32 v173, v173
    v_exp_f32 v174, v174
    v_exp_f32 v175, v175
    v_exp_f32 v144, v144
    v_exp_f32 v145, v145
    v_smfmac_f32_32x32x32_bf16 v[96:111], a[20:23], v[168:175], v4
    s_add_u32 m0, s96, 32768
    v_exp_f32 v146, v146
    v_exp_f32 v147, v147
    v_exp_f32 v148, v148
    v_mfma_f32_32x32x16_bf16 v[160:175], a[12:15], v[212:215], v[64:79]
    s_add_u32 s78, s52, s28
    v_exp_f32 v149, v149
    v_exp_f32 v150, v150
    v_exp_f32 v151, v151
    v_exp_f32 v152, v152
    v_exp_f32 v153, v153
    v_smfmac_f32_32x32x32_bf16 v[112:127], a[16:19], v[144:151], v4
    s_addc_u32 s79, s53, 0
    global_load_lds_dwordx4 v5, s[78:79]
    global_load_lds_dwordx4 v7, s[78:79] offset:1024
    v_exp_f32 v154, v154
    v_exp_f32 v155, v155
    v_exp_f32 v156, v156
    v_exp_f32 v157, v157
    v_exp_f32 v158, v158
    v_exp_f32 v159, v159
    v_exp_f32 v160, v160
    v_exp_f32 v161, v161
    v_smfmac_f32_32x32x32_bf16 v[112:127], a[20:23], v[152:159], v4
    s_waitcnt vmcnt(29)
    v_exp_f32 v162, v162
    v_exp_f32 v163, v163
    v_exp_f32 v164, v164
    v_mfma_f32_32x32x16_bf16 v[144:159], a[24:27], v[200:203], v[16:31]
    s_waitcnt lgkmcnt(0)
    v_exp_f32 v165, v165
    v_exp_f32 v166, v166
    v_exp_f32 v167, v167
    v_exp_f32 v168, v168
    v_exp_f32 v169, v169
    v_smfmac_f32_32x32x32_bf16 v[128:143], a[16:19], v[160:167], v4
    s_add_u32 m0, s96, 0
    v_exp_f32 v170, v170
    v_exp_f32 v171, v171
    v_exp_f32 v172, v172
    v_exp_f32 v173, v173
    v_exp_f32 v174, v174
    v_exp_f32 v175, v175
    v_exp_f32 v144, v144
    v_exp_f32 v145, v145
    v_smfmac_f32_32x32x32_bf16 v[128:143], a[20:23], v[168:175], v4
    s_add_u32 s78, s52, s29
    global_load_dwordx4 a[12:15], v248, s[60:61] offset:-2048 sc1
    global_load_dwordx4 a[16:19], v3, s[60:61] offset:-1024 sc1
    global_load_dwordx4 a[20:23], v3, s[60:61] offset:-512 sc1
    v_exp_f32 v146, v146
    v_exp_f32 v147, v147
    v_exp_f32 v148, v148
    v_mfma_f32_32x32x16_bf16 v[160:175], a[24:27], v[204:207], v[32:47]
    s_addc_u32 s79, s53, 0
    v_exp_f32 v149, v149
    v_exp_f32 v150, v150
    v_exp_f32 v151, v151
    v_exp_f32 v152, v152
    v_exp_f32 v153, v153
    v_smfmac_f32_32x32x32_bf16 v[80:95], a[28:31], v[144:151], v4
    v_exp_f32 v154, v154
    v_exp_f32 v155, v155
    v_exp_f32 v156, v156
    v_exp_f32 v157, v157
    v_exp_f32 v158, v158
    v_exp_f32 v159, v159
    v_exp_f32 v160, v160
    v_exp_f32 v161, v161
    v_smfmac_f32_32x32x32_bf16 v[80:95], a[32:35], v[152:159], v4
    v_exp_f32 v162, v162
    v_exp_f32 v163, v163
    v_exp_f32 v164, v164
    v_mfma_f32_32x32x16_bf16 v[144:159], a[24:27], v[208:211], v[48:63]
    v_exp_f32 v165, v165
    v_exp_f32 v166, v166
    v_exp_f32 v167, v167
    v_exp_f32 v168, v168
    v_exp_f32 v169, v169
    v_smfmac_f32_32x32x32_bf16 v[96:111], a[28:31], v[160:167], v4
    global_load_lds_dwordx4 v5, s[78:79]
    global_load_lds_dwordx4 v7, s[78:79] offset:1024
    v_exp_f32 v170, v170
    v_exp_f32 v171, v171
    v_exp_f32 v172, v172
    v_exp_f32 v173, v173
    v_exp_f32 v174, v174
    v_exp_f32 v175, v175
    v_exp_f32 v144, v144
    v_exp_f32 v145, v145
    v_smfmac_f32_32x32x32_bf16 v[96:111], a[32:35], v[168:175], v4
    s_add_u32 m0, s96, 2048
    v_exp_f32 v146, v146
    v_exp_f32 v147, v147
    v_exp_f32 v148, v148
    v_mfma_f32_32x32x16_bf16 v[160:175], a[24:27], v[212:215], v[64:79]
    s_add_u32 s78, s52, s30
    v_exp_f32 v149, v149
    v_exp_f32 v150, v150
    v_exp_f32 v151, v151
    v_exp_f32 v152, v152
    v_exp_f32 v153, v153
    v_smfmac_f32_32x32x32_bf16 v[112:127], a[28:31], v[144:151], v4
    s_addc_u32 s79, s53, 0
    global_load_lds_dwordx4 v5, s[78:79]
    global_load_lds_dwordx4 v7, s[78:79] offset:1024
    v_exp_f32 v154, v154
    v_exp_f32 v155, v155
    v_exp_f32 v156, v156
    v_exp_f32 v157, v157
    v_exp_f32 v158, v158
    v_exp_f32 v159, v159
    v_exp_f32 v160, v160
    v_exp_f32 v161, v161
    v_smfmac_f32_32x32x32_bf16 v[112:127], a[32:35], v[152:159], v4
    s_waitcnt vmcnt(31)
    v_exp_f32 v162, v162
    v_exp_f32 v163, v163
    v_exp_f32 v164, v164
    v_mfma_f32_32x32x16_bf16 v[144:159], a[36:39], v[200:203], v[16:31]
    v_exp_f32 v165, v165
    v_exp_f32 v166, v166
    v_exp_f32 v167, v167
    v_exp_f32 v168, v168
    v_exp_f32 v169, v169
    v_smfmac_f32_32x32x32_bf16 v[128:143], a[28:31], v[160:167], v4
    s_add_u32 m0, s96, 4096
    v_exp_f32 v170, v170
    v_exp_f32 v171, v171
    v_exp_f32 v172, v172
    v_exp_f32 v173, v173
    v_exp_f32 v174, v174
    v_exp_f32 v175, v175
    v_exp_f32 v144, v144
    v_exp_f32 v145, v145
    v_smfmac_f32_32x32x32_bf16 v[128:143], a[32:35], v[168:175], v4
    s_add_u32 s78, s52, s31
    global_load_dwordx4 a[24:27], v248, s[60:61] offset:0 sc1
    global_load_dwordx4 a[28:31], v3, s[60:61] offset:1024 sc1
    global_load_dwordx4 a[32:35], v3, s[60:61] offset:1536 sc1
    v_exp_f32 v146, v146
    v_exp_f32 v147, v147
    v_exp_f32 v148, v148
    v_mfma_f32_32x32x16_bf16 v[160:175], a[36:39], v[204:207], v[32:47]
    s_addc_u32 s79, s53, 0
    v_exp_f32 v149, v149
    v_exp_f32 v150, v150
    v_exp_f32 v151, v151
    v_exp_f32 v152, v152
    v_exp_f32 v153, v153
    v_smfmac_f32_32x32x32_bf16 v[80:95], a[40:43], v[144:151], v4
    v_exp_f32 v154, v154
    v_exp_f32 v155, v155
    v_exp_f32 v156, v156
    v_exp_f32 v157, v157
    v_exp_f32 v158, v158
    v_exp_f32 v159, v159
    v_exp_f32 v160, v160
    v_exp_f32 v161, v161
    v_smfmac_f32_32x32x32_bf16 v[80:95], a[44:47], v[152:159], v4
    v_exp_f32 v162, v162
    v_exp_f32 v163, v163
    v_exp_f32 v164, v164
    v_mfma_f32_32x32x16_bf16 v[144:159], a[36:39], v[208:211], v[48:63]
    v_exp_f32 v165, v165
    v_exp_f32 v166, v166
    v_exp_f32 v167, v167
    v_exp_f32 v168, v168
    v_exp_f32 v169, v169
    v_smfmac_f32_32x32x32_bf16 v[96:111], a[40:43], v[160:167], v4
    global_load_lds_dwordx4 v5, s[78:79]
    global_load_lds_dwordx4 v7, s[78:79] offset:1024
    v_exp_f32 v170, v170
    v_exp_f32 v171, v171
    v_exp_f32 v172, v172
    v_exp_f32 v173, v173
    v_exp_f32 v174, v174
    v_exp_f32 v175, v175
    v_exp_f32 v144, v144
    v_exp_f32 v145, v145
    v_smfmac_f32_32x32x32_bf16 v[96:111], a[44:47], v[168:175], v4
    s_add_u32 m0, s96, 6144
    v_exp_f32 v146, v146
    v_exp_f32 v147, v147
    v_exp_f32 v148, v148
    v_mfma_f32_32x32x16_bf16 v[160:175], a[36:39], v[212:215], v[64:79]
    s_add_u32 s78, s52, s32
    v_exp_f32 v149, v149
    v_exp_f32 v150, v150
    v_exp_f32 v151, v151
    v_exp_f32 v152, v152
    v_exp_f32 v153, v153
    v_smfmac_f32_32x32x32_bf16 v[112:127], a[40:43], v[144:151], v4
    s_addc_u32 s79, s53, 0
    global_load_lds_dwordx4 v5, s[78:79]
    global_load_lds_dwordx4 v7, s[78:79] offset:1024
    v_exp_f32 v154, v154
    v_exp_f32 v155, v155
    v_exp_f32 v156, v156
    v_exp_f32 v157, v157
    v_exp_f32 v158, v158
    v_exp_f32 v159, v159
    v_exp_f32 v160, v160
    v_exp_f32 v161, v161
    v_smfmac_f32_32x32x32_bf16 v[112:127], a[44:47], v[152:159], v4
    s_waitcnt vmcnt(31)
    v_exp_f32 v162, v162
    v_exp_f32 v163, v163
    v_exp_f32 v164, v164
    v_mfma_f32_32x32x16_bf16 v[144:159], a[48:51], v[200:203], v[16:31]
    v_exp_f32 v165, v165
    v_exp_f32 v166, v166
    v_exp_f32 v167, v167
    v_exp_f32 v168, v168
    v_exp_f32 v169, v169
    v_smfmac_f32_32x32x32_bf16 v[128:143], a[40:43], v[160:167], v4
    s_add_u32 m0, s96, 8192
    buffer_load_dword v8, v6, s[60:63], s92 offen sc1
    v_exp_f32 v170, v170
    v_exp_f32 v171, v171
    v_exp_f32 v172, v172
    v_exp_f32 v173, v173
    v_exp_f32 v174, v174
    v_exp_f32 v175, v175
    v_exp_f32 v144, v144
    v_exp_f32 v145, v145
    v_smfmac_f32_32x32x32_bf16 v[128:143], a[44:47], v[168:175], v4
    s_add_u32 s78, s52, s33
    global_load_dwordx4 a[36:39], v248, s[60:61] offset:2048 sc1
    global_load_dwordx4 a[40:43], v3, s[60:61] offset:3072 sc1
    global_load_dwordx4 a[44:47], v3, s[60:61] offset:3584 sc1
    v_exp_f32 v146, v146
    v_exp_f32 v147, v147
    v_exp_f32 v148, v148
    v_mfma_f32_32x32x16_bf16 v[160:175], a[48:51], v[204:207], v[32:47]
    s_addc_u32 s79, s53, 0
    v_add_u32 v248, 0x2000, v248
    v_add_u32 v3, v13, v3
    v_exp_f32 v149, v149
    v_exp_f32 v150, v150
    v_exp_f32 v151, v151
    v_exp_f32 v152, v152
    v_exp_f32 v153, v153
    v_smfmac_f32_32x32x32_bf16 v[80:95], a[52:55], v[144:151], v4
    v_exp_f32 v154, v154
    v_exp_f32 v155, v155
    v_exp_f32 v156, v156
    v_exp_f32 v157, v157
    v_exp_f32 v158, v158
    v_exp_f32 v159, v159
    v_exp_f32 v160, v160
    v_exp_f32 v161, v161
    v_smfmac_f32_32x32x32_bf16 v[80:95], a[56:59], v[152:159], v4
    v_exp_f32 v162, v162
    v_exp_f32 v163, v163
    v_exp_f32 v164, v164
    v_mfma_f32_32x32x16_bf16 v[144:159], a[48:51], v[208:211], v[48:63]
    v_exp_f32 v165, v165
    v_exp_f32 v166, v166
    v_exp_f32 v167, v167
    v_exp_f32 v168, v168
    v_exp_f32 v169, v169
    v_smfmac_f32_32x32x32_bf16 v[96:111], a[52:55], v[160:167], v4
    global_load_lds_dwordx4 v5, s[78:79]
    global_load_lds_dwordx4 v7, s[78:79] offset:1024
    v_exp_f32 v170, v170
    v_exp_f32 v171, v171
    v_exp_f32 v172, v172
    v_exp_f32 v173, v173
    v_exp_f32 v174, v174
    v_exp_f32 v175, v175
    v_exp_f32 v144, v144
L_pad7:
    s_cbranch_execz L_pad11
    v_exp_f32 v145, v145
    v_smfmac_f32_32x32x32_bf16 v[96:111], a[56:59], v[168:175], v4
    s_add_u32 m0, s96, 10240
    v_exp_f32 v146, v146
    v_exp_f32 v147, v147
    v_exp_f32 v148, v148
    v_mfma_f32_32x32x16_bf16 v[160:175], a[48:51], v[212:215], v[64:79]
    s_add_u32 s78, s52, s34
    v_exp_f32 v149, v149
    v_exp_f32 v150, v150
    v_exp_f32 v151, v151
    v_exp_f32 v152, v152
    v_exp_f32 v153, v153
    v_smfmac_f32_32x32x32_bf16 v[112:127], a[52:55], v[144:151], v4
    s_addc_u32 s79, s53, 0
    global_load_lds_dwordx4 v5, s[78:79]
    global_load_lds_dwordx4 v7, s[78:79] offset:1024
    v_exp_f32 v154, v154
    v_exp_f32 v155, v155
    v_exp_f32 v156, v156
    v_exp_f32 v157, v157
    v_exp_f32 v158, v158
    v_exp_f32 v159, v159
    v_exp_f32 v160, v160
    v_exp_f32 v161, v161
    v_smfmac_f32_32x32x32_bf16 v[112:127], a[56:59], v[152:159], v4
    s_waitcnt vmcnt(33)
    v_exp_f32 v162, v162
    v_exp_f32 v163, v163
    v_exp_f32 v164, v164
    v_mfma_f32_32x32x16_bf16 v[144:159], a[60:63], v[200:203], v[16:31]
    v_exp_f32 v165, v165
    v_exp_f32 v166, v166
    v_exp_f32 v167, v167
    v_exp_f32 v168, v168
    v_exp_f32 v169, v169
    v_smfmac_f32_32x32x32_bf16 v[128:143], a[52:55], v[160:167], v4
    s_add_u32 m0, s96, 12288
    v_exp_f32 v170, v170
    v_exp_f32 v171, v171
    v_exp_f32 v172, v172
    v_exp_f32 v173, v173
    v_exp_f32 v174, v174
    v_exp_f32 v175, v175
    v_exp_f32 v144, v144
    v_exp_f32 v145, v145
    v_smfmac_f32_32x32x32_bf16 v[128:143], a[56:59], v[168:175], v4
    s_add_u32 s78, s52, s35
    global_load_dwordx4 a[48:51], v248, s[60:61] offset:-4096 sc1
    global_load_dwordx4 a[52:55], v3, s[60:61] offset:-3072 sc1
    global_load_dwordx4 a[56:59], v3, s[60:61] offset:-2560 sc1
    v_exp_f32 v146, v146
    v_exp_f32 v147, v147
    v_exp_f32 v148, v148
    v_mfma_f32_32x32x16_bf16 v[160:175], a[60:63], v[204:207], v[32:47]
    s_addc_u32 s79, s53, 0
    v_exp_f32 v149, v149
    v_exp_f32 v150, v150
    v_exp_f32 v151, v151
    v_exp_f32 v152, v152
    v_exp_f32 v153, v153
    v_smfmac_f32_32x32x32_bf16 v[80:95], a[64:67], v[144:151], v4
    v_exp_f32 v154, v154
    v_exp_f32 v155, v155
    v_exp_f32 v156, v156
    v_exp_f32 v157, v157
    v_exp_f32 v158, v158
    v_exp_f32 v159, v159
    v_exp_f32 v160, v160
    v_exp_f32 v161, v161
    v_smfmac_f32_32x32x32_bf16 v[80:95], a[68:71], v[152:159], v4
    v_exp_f32 v162, v162
    v_exp_f32 v163, v163
    v_exp_f32 v164, v164
    v_mfma_f32_32x32x16_bf16 v[144:159], a[60:63], v[208:211], v[48:63]
    v_exp_f32 v165, v165
    v_exp_f32 v166, v166
    v_exp_f32 v167, v167
    v_exp_f32 v168, v168
    v_exp_f32 v169, v169
    v_smfmac_f32_32x32x32_bf16 v[96:111], a[64:67], v[160:167], v4
    global_load_lds_dwordx4 v5, s[78:79]
    global_load_lds_dwordx4 v7, s[78:79] offset:1024
    v_exp_f32 v170, v170
    v_exp_f32 v171, v171
    v_exp_f32 v172, v172
    v_exp_f32 v173, v173
    v_exp_f32 v174, v174
    v_exp_f32 v175, v175
    v_exp_f32 v144, v144
    v_exp_f32 v145, v145
    v_smfmac_f32_32x32x32_bf16 v[96:111], a[68:71], v[168:175], v4
    s_add_u32 m0, s96, 14336
    v_exp_f32 v146, v146
    v_exp_f32 v147, v147
    v_exp_f32 v148, v148
    v_mfma_f32_32x32x16_bf16 v[160:175], a[60:63], v[212:215], v[64:79]
    s_add_u32 s78, s52, s44
    v_exp_f32 v149, v149
    v_exp_f32 v150, v150
    v_exp_f32 v151, v151
    v_exp_f32 v152, v152
    v_exp_f32 v153, v153
    v_smfmac_f32_32x32x32_bf16 v[112:127], a[64:67], v[144:151], v4
    s_addc_u32 s79, s53, 0
    global_load_lds_dwordx4 v5, s[78:79]
    global_load_lds_dwordx4 v7, s[78:79] offset:1024
    v_exp_f32 v154, v154
    v_exp_f32 v155, v155
    v_exp_f32 v156, v156
    v_exp_f32 v157, v157
    v_exp_f32 v158, v158
    v_exp_f32 v159, v159
    v_exp_f32 v160, v160
    v_exp_f32 v161, v161
    v_smfmac_f32_32x32x32_bf16 v[112:127], a[68:71], v[152:159], v4
    s_waitcnt vmcnt(33)
    v_exp_f32 v162, v162
    v_exp_f32 v163, v163
    v_exp_f32 v164, v164
    v_mfma_f32_32x32x16_bf16 v[144:159], a[0:3], v[200:203], v[16:31]
    s_waitcnt vmcnt(14)
    v_exp_f32 v165, v165
    v_exp_f32 v166, v166
    v_exp_f32 v167, v167
    v_exp_f32 v168, v168
    v_exp_f32 v169, v169
    v_smfmac_f32_32x32x32_bf16 v[128:143], a[64:67], v[160:167], v4
    v_cmp_ne_u32 vcc, 1, v8
    s_cbranch_vccnz L_h_retry
L_h_ok:
    v_exp_f32 v170, v170
    v_exp_f32 v171, v171
    v_exp_f32 v172, v172
    v_exp_f32 v173, v173
    v_exp_f32 v174, v174
    v_exp_f32 v175, v175
    v_exp_f32 v144, v144
    v_exp_f32 v145, v145
    v_smfmac_f32_32x32x32_bf16 v[128:143], a[68:71], v[168:175], v4
    s_add_u32 s100, s64, s38
    global_load_dwordx4 a[60:63], v248, s[60:61] offset:-2048 sc1
    global_load_dwordx4 a[64:67], v3, s[60:61] offset:-1024 sc1
    global_load_dwordx4 a[68:71], v3, s[60:61] offset:-512 sc1
    v_exp_f32 v146, v146
    v_exp_f32 v147, v147
    v_exp_f32 v148, v148
    v_mfma_f32_32x32x16_bf16 v[160:175], a[0:3], v[204:207], v[32:47]
    s_addc_u32 s101, s65, 0
    v_exp_f32 v149, v149
    v_exp_f32 v150, v150
    v_exp_f32 v151, v151
    v_exp_f32 v152, v152
    v_exp_f32 v153, v153
    v_smfmac_f32_32x32x32_bf16 v[80:95], a[4:7], v[144:151], v4
    s_add_u32 s90, s64, s39
    v_exp_f32 v154, v154
    v_exp_f32 v155, v155
    v_exp_f32 v156, v156
    v_exp_f32 v157, v157
    v_exp_f32 v158, v158
    v_exp_f32 v159, v159
    v_exp_f32 v160, v160
    v_exp_f32 v161, v161
    v_smfmac_f32_32x32x32_bf16 v[80:95], a[8:11], v[152:159], v4
    s_addc_u32 s91, s65, 0
    v_exp_f32 v162, v162
    v_exp_f32 v163, v163
    v_exp_f32 v164, v164
    v_mfma_f32_32x32x16_bf16 v[144:159], a[0:3], v[208:211], v[48:63]
    v_exp_f32 v165, v165
    v_exp_f32 v166, v166
    v_exp_f32 v167, v167
    v_exp_f32 v168, v168
    v_exp_f32_e64 v169, v169
    v_smfmac_f32_32x32x32_bf16 v[96:111], a[4:7], v[160:167], v4
    global_load_dwordx4 a[72:75], v15, s[100:101] sc1
    global_load_dwordx4 a[76:79], v14, s[100:101] sc1
    global_load_dwordx4 a[80:83], v15, s[90:91] sc1
    global_load_dwordx4 a[84:87], v14, s[90:91] sc1
    v_exp_f32 v170, v170
    v_exp_f32 v171, v171
    v_exp_f32 v172, v172
    v_exp_f32 v173, v173
    v_exp_f32 v174, v174
    v_exp_f32 v175, v175
    v_exp_f32 v144, v144
    v_exp_f32 v145, v145
    v_smfmac_f32_32x32x32_bf16 v[96:111], a[8:11], v[168:175], v4
    v_exp_f32 v146, v146
    v_exp_f32 v147, v147
    v_exp_f32 v148, v148
    v_mfma_f32_32x32x16_bf16 v[160:175], a[0:3], v[212:215], v[64:79]
    s_add_u32 s100, s64, s22
    v_exp_f32 v149, v149
    v_exp_f32 v150, v150
    v_exp_f32 v151, v151
    v_exp_f32 v152, v152
    v_exp_f32 v153, v153
    v_smfmac_f32_32x32x32_bf16 v[112:127], a[4:7], v[144:151], v4
    s_addc_u32 s101, s65, 0
    v_exp_f32 v154, v154
    v_exp_f32 v155, v155
    v_exp_f32 v156, v156
    v_exp_f32 v157, v157
    v_exp_f32 v158, v158
    v_exp_f32 v159, v159
    v_exp_f32 v160, v160
    v_exp_f32 v161, v161
    v_smfmac_f32_32x32x32_bf16 v[112:127], a[8:11], v[152:159], v4
    v_exp_f32 v162, v162
    v_exp_f32 v163, v163
    v_exp_f32 v164, v164
    v_mfma_f32_32x32x16_bf16 v[144:159], a[12:15], v[200:203], v[16:31]
    v_exp_f32 v165, v165
    v_exp_f32 v166, v166
    v_exp_f32 v167, v167
    v_exp_f32 v168, v168
    v_exp_f32 v169, v169
    v_smfmac_f32_32x32x32_bf16 v[128:143], a[4:7], v[160:167], v4
    v_exp_f32 v170, v170
    v_exp_f32 v171, v171
    v_exp_f32 v172, v172
    v_exp_f32 v173, v173
    v_exp_f32 v174, v174
    v_exp_f32 v175, v175
    v_exp_f32 v144, v144
    v_exp_f32 v145, v145
    v_smfmac_f32_32x32x32_bf16 v[128:143], a[8:11], v[168:175], v4
    global_load_dwordx4 a[0:3], v248, s[60:61] offset:0 sc1
    global_load_dwordx4 a[4:7], v3, s[60:61] offset:1024 sc1
    global_load_dwordx4 a[8:11], v3, s[60:61] offset:1536 sc1
    v_exp_f32 v146, v146
    v_exp_f32 v147, v147
    v_exp_f32 v148, v148
    v_mfma_f32_32x32x16_bf16 v[160:175], a[12:15], v[204:207], v[32:47]
    v_exp_f32 v149, v149
    v_exp_f32 v150, v150
    v_exp_f32 v151, v151
    v_exp_f32 v152, v152
    v_exp_f32 v153, v153
    v_smfmac_f32_32x32x32_bf16 v[80:95], a[16:19], v[144:151], v4
    v_exp_f32 v154, v154
    v_exp_f32 v155, v155
    v_exp_f32 v156, v156
    v_exp_f32 v157, v157
    v_exp_f32 v158, v158
    v_exp_f32 v159, v159
    v_exp_f32 v160, v160
    v_exp_f32 v161, v161
    v_smfmac_f32_32x32x32_bf16 v[80:95], a[20:23], v[152:159], v4
    v_exp_f32 v162, v162
    v_exp_f32 v163, v163
    v_exp_f32 v164, v164
    v_mfma_f32_32x32x16_bf16 v[144:159], a[12:15], v[208:211], v[48:63]
    v_exp_f32 v165, v165
    v_exp_f32 v166, v166
    v_exp_f32 v167, v167
    v_exp_f32 v168, v168
    v_exp_f32 v169, v169
    v_smfmac_f32_32x32x32_bf16 v[96:111], a[16:19], v[160:167], v4
    global_load_dwordx4 a[88:91], v15, s[100:101] sc1
    global_load_dwordx4 a[92:95], v14, s[100:101] sc1
    buffer_load_dwordx4 a[96:99], v15, s[64:67], s23 offen sc1
    buffer_load_dwordx4 a[100:103], v14, s[64:67], s23 offen sc1
    v_exp_f32 v170, v170
    v_exp_f32 v171, v171
    v_exp_f32 v172, v172
    v_exp_f32 v173, v173
    v_exp_f32 v174, v174
    v_exp_f32 v175, v175
    v_exp_f32 v144, v144
    v_exp_f32 v145, v145
    v_smfmac_f32_32x32x32_bf16 v[96:111], a[20:23], v[168:175], v4
    s_add_u32 s100, s64, s24
    v_exp_f32 v146, v146
    v_exp_f32 v147, v147
    v_exp_f32 v148, v148
    v_mfma_f32_32x32x16_bf16 v[160:175], a[12:15], v[212:215], v[64:79]
    s_addc_u32 s101, s65, 0
    v_exp_f32 v149, v149
    v_exp_f32 v150, v150
    v_exp_f32 v151, v151
    v_exp_f32 v152, v152
    v_exp_f32 v153, v153
    v_smfmac_f32_32x32x32_bf16 v[112:127], a[16:19], v[144:151], v4
    v_exp_f32 v154, v154
    v_exp_f32 v155, v155
    v_exp_f32 v156, v156
    v_exp_f32 v157, v157
    v_exp_f32 v158, v158
    v_exp_f32 v159, v159
    v_exp_f32 v160, v160
    v_exp_f32 v161, v161
    v_smfmac_f32_32x32x32_bf16 v[112:127], a[20:23], v[152:159], v4
    v_exp_f32 v162, v162
    v_exp_f32 v163, v163
    v_exp_f32 v164, v164
    v_mfma_f32_32x32x16_bf16 v[144:159], a[24:27], v[200:203], v[16:31]
    s_add_u32 s90, s64, s25
    v_exp_f32 v165, v165
    v_exp_f32 v166, v166
    v_exp_f32 v167, v167
    v_exp_f32 v168, v168
    v_exp_f32 v169, v169
    v_smfmac_f32_32x32x32_bf16 v[128:143], a[16:19], v[160:167], v4
    s_addc_u32 s91, s65, 0
    v_exp_f32 v170, v170
    v_exp_f32 v171, v171
    v_exp_f32 v172, v172
    v_exp_f32 v173, v173
    v_exp_f32 v174, v174
    v_exp_f32 v175, v175
    v_exp_f32 v144, v144
    v_exp_f32 v145, v145
    v_smfmac_f32_32x32x32_bf16 v[128:143], a[20:23], v[168:175], v4
    global_load_dwordx4 a[12:15], v248, s[60:61] offset:2048 sc1
    global_load_dwordx4 a[16:19], v3, s[60:61] offset:3072 sc1
    global_load_dwordx4 a[20:23], v3, s[60:61] offset:3584 sc1
    v_exp_f32 v146, v146
    v_exp_f32 v147, v147
    v_exp_f32 v148, v148
    v_mfma_f32_32x32x16_bf16 v[160:175], a[24:27], v[204:207], v[32:47]
    v_exp_f32 v149, v149
    v_exp_f32 v150, v150
    v_exp_f32 v151, v151
    v_exp_f32 v152, v152
    v_exp_f32 v153, v153
    v_smfmac_f32_32x32x32_bf16 v[80:95], a[28:31], v[144:151], v4
    v_exp_f32 v154, v154
    v_exp_f32 v155, v155
    v_exp_f32 v156, v156
    v_exp_f32 v157, v157
    v_exp_f32 v158, v158
    v_exp_f32 v159, v159
    v_exp_f32 v160, v160
    v_exp_f32 v161, v161
    v_smfmac_f32_32x32x32_bf16 v[80:95], a[32:35], v[152:159], v4
    v_exp_f32 v162, v162
    v_exp_f32 v163, v163
    v_exp_f32 v164, v164
    v_mfma_f32_32x32x16_bf16 v[144:159], a[24:27], v[208:211], v[48:63]
    v_exp_f32 v165, v165
    v_exp_f32 v166, v166
    v_exp_f32 v167, v167
    v_exp_f32 v168, v168
    v_exp_f32 v169, v169
    v_smfmac_f32_32x32x32_bf16 v[96:111], a[28:31], v[160:167], v4
    global_load_dwordx4 a[104:107], v15, s[100:101] sc1
    global_load_dwordx4 a[108:111], v14, s[100:101] sc1
    global_load_dwordx4 a[112:115], v15, s[90:91] sc1
    global_load_dwordx4 a[116:119], v14, s[90:91] sc1
    v_exp_f32 v170, v170
    v_exp_f32 v171, v171
    v_exp_f32 v172, v172
    v_exp_f32 v173, v173
    v_exp_f32 v174, v174
    v_exp_f32 v175, v175
    v_exp_f32 v144, v144
    v_exp_f32 v145, v145
    v_smfmac_f32_32x32x32_bf16 v[96:111], a[32:35], v[168:175], v4
    s_add_u32 s100, s64, s26
    v_exp_f32 v146, v146
    v_exp_f32 v147, v147
    v_exp_f32 v148, v148
    v_mfma_f32_32x32x16_bf16 v[160:175], a[24:27], v[212:215], v[64:79]
    s_addc_u32 s101, s65, 0
    v_exp_f32 v149, v149
    v_exp_f32 v150, v150
    v_exp_f32 v151, v151
    v_exp_f32 v152, v152
    v_exp_f32 v153, v153
    v_smfmac_f32_32x32x32_bf16 v[112:127], a[28:31], v[144:151], v4
    v_exp_f32 v154, v154
    v_exp_f32 v155, v155
    v_exp_f32 v156, v156
    v_exp_f32 v157, v157
    v_exp_f32 v158, v158
    v_exp_f32 v159, v159
    v_exp_f32 v160, v160
    v_exp_f32 v161, v161
    v_smfmac_f32_32x32x32_bf16 v[112:127], a[32:35], v[152:159], v4
    s_waitcnt vmcnt(32)
    v_exp_f32 v162, v162
    v_exp_f32 v163, v163
    v_exp_f32 v164, v164
    v_mfma_f32_32x32x16_bf16 v[144:159], a[36:39], v[200:203], v[16:31]
    s_add_u32 s90, s64, s27
    v_exp_f32 v165, v165
    v_exp_f32 v166, v166
    v_exp_f32 v167, v167
    v_exp_f32 v168, v168
    v_exp_f32_e64 v169, v169
    v_smfmac_f32_32x32x32_bf16 v[128:143], a[28:31], v[160:167], v4
    s_addc_u32 s91, s65, 0
    global_load_dwordx4 a[120:123], v15, s[100:101] sc1
    global_load_dwordx4 a[124:127], v14, s[100:101] sc1
    global_load_dwordx4 a[128:131], v15, s[90:91] sc1
    global_load_dwordx4 a[132:135], v14, s[90:91] sc1
    v_exp_f32 v170, v170
    v_exp_f32 v171, v171
    v_exp_f32 v172, v172
    v_exp_f32 v173, v173
    v_exp_f32 v174, v174
    v_exp_f32 v175, v175
    v_exp_f32 v144, v144
    v_exp_f32 v145, v145
    v_smfmac_f32_32x32x32_bf16 v[128:143], a[32:35], v[168:175], v4
    s_add_u32 s100, s64, s28
    v_exp_f32 v146, v146
    v_exp_f32 v147, v147
    v_exp_f32 v148, v148
    v_mfma_f32_32x32x16_bf16 v[160:175], a[36:39], v[204:207], v[32:47]
    s_addc_u32 s101, s65, 0
    v_exp_f32 v149, v149
    v_exp_f32 v150, v150
    v_exp_f32 v151, v151
    v_exp_f32 v152, v152
    v_exp_f32 v153, v153
    v_smfmac_f32_32x32x32_bf16 v[80:95], a[40:43], v[144:151], v4
    s_add_u32 s90, s64, s29
    v_exp_f32 v154, v154
    v_exp_f32 v155, v155
    v_exp_f32 v156, v156
    v_exp_f32 v157, v157
    v_exp_f32 v158, v158
    v_exp_f32 v159, v159
    v_exp_f32 v160, v160
    v_exp_f32 v161, v161
    v_smfmac_f32_32x32x32_bf16 v[80:95], a[44:47], v[152:159], v4
    s_addc_u32 s91, s65, 0
    v_exp_f32 v162, v162
    v_exp_f32 v163, v163
    v_exp_f32 v164, v164
    v_mfma_f32_32x32x16_bf16 v[144:159], a[36:39], v[208:211], v[48:63]
    v_exp_f32 v165, v165
    v_exp_f32 v166, v166
    v_exp_f32 v167, v167
    v_exp_f32 v168, v168
    v_exp_f32 v169, v169
    v_smfmac_f32_32x32x32_bf16 v[96:111], a[40:43], v[160:167], v4
    global_load_dwordx4 a[136:139], v15, s[100:101] sc1
    global_load_dwordx4 a[140:143], v14, s[100:101] sc1
    global_load_dwordx4 a[144:147], v15, s[90:91] sc1
    global_load_dwordx4 a[148:151], v14, s[90:91] sc1
    v_exp_f32 v170, v170
    v_exp_f32 v171, v171
    v_exp_f32 v172, v172
    v_exp_f32 v173, v173
    v_exp_f32 v174, v174
    v_exp_f32 v175, v175
    v_exp_f32 v144, v144
    v_exp_f32 v145, v145
    v_smfmac_f32_32x32x32_bf16 v[96:111], a[44:47], v[168:175], v4
    s_add_u32 s100, s64, s30
    v_exp_f32 v146, v146
    v_exp_f32 v147, v147
    v_exp_f32 v148, v148
    v_mfma_f32_32x32x16_bf16 v[160:175], a[36:39], v[212:215], v[64:79]
    s_addc_u32 s101, s65, 0
    v_exp_f32 v149, v149
    v_exp_f32 v150, v150
    v_exp_f32 v151, v151
    v_exp_f32 v152, v152
    v_exp_f32 v153, v153
    v_smfmac_f32_32x32x32_bf16 v[112:127], a[40:43], v[144:151], v4
    v_exp_f32 v154, v154
    v_exp_f32 v155, v155
    v_exp_f32 v156, v156
    v_exp_f32 v157, v157
    v_exp_f32 v158, v158
    v_exp_f32 v159, v159
    v_exp_f32 v160, v160
    v_exp_f32 v161, v161
    v_smfmac_f32_32x32x32_bf16 v[112:127], a[44:47], v[152:159], v4
    s_waitcnt vmcnt(33)
    v_exp_f32 v162, v162
    v_exp_f32 v163, v163
    v_exp_f32 v164, v164
    v_mfma_f32_32x32x16_bf16 v[144:159], a[48:51], v[200:203], v[16:31]
    s_add_u32 s90, s64, s31
    v_exp_f32 v165, v165
    v_exp_f32 v166, v166
    v_exp_f32 v167, v167
    v_exp_f32 v168, v168
    v_exp_f32_e64 v169, v169
    v_smfmac_f32_32x32x32_bf16 v[128:143], a[40:43], v[160:167], v4
    s_addc_u32 s91, s65, 0
    global_load_dwordx4 a[152:155], v15, s[100:101] sc1
    global_load_dwordx4 a[156:159], v14, s[100:101] sc1
    global_load_dwordx4 a[160:163], v15, s[90:91] sc1
    global_load_dwordx4 a[164:167], v14, s[90:91] sc1
    v_exp_f32 v170, v170
    v_exp_f32 v171, v171
    v_exp_f32 v172, v172
    v_exp_f32 v173, v173
    v_exp_f32 v174, v174
    v_exp_f32 v175, v175
    v_exp_f32 v144, v144
    v_exp_f32 v145, v145
    v_smfmac_f32_32x32x32_bf16 v[128:143], a[44:47], v[168:175], v4
    s_add_u32 s100, s64, s32
    v_exp_f32 v146, v146
    v_exp_f32 v147, v147
    v_exp_f32 v148, v148
    v_mfma_f32_32x32x16_bf16 v[160:175], a[48:51], v[204:207], v[32:47]
    s_addc_u32 s101, s65, 0
    v_exp_f32 v149, v149
    v_exp_f32 v150, v150
    v_exp_f32 v151, v151
    v_exp_f32 v152, v152
    v_exp_f32 v153, v153
    v_smfmac_f32_32x32x32_bf16 v[80:95], a[52:55], v[144:151], v4
    s_add_u32 s90, s64, s33
    v_exp_f32 v154, v154
    v_exp_f32 v155, v155
    v_exp_f32 v156, v156
    v_exp_f32 v157, v157
    v_exp_f32 v158, v158
    v_exp_f32 v159, v159
    v_exp_f32 v160, v160
    v_exp_f32 v161, v161
    v_smfmac_f32_32x32x32_bf16 v[80:95], a[56:59], v[152:159], v4
    s_addc_u32 s91, s65, 0
    v_exp_f32 v162, v162
    v_exp_f32 v163, v163
    v_exp_f32 v164, v164
    v_mfma_f32_32x32x16_bf16 v[144:159], a[48:51], v[208:211], v[48:63]
    v_exp_f32 v165, v165
    v_exp_f32 v166, v166
    v_exp_f32 v167, v167
    v_exp_f32 v168, v168
    v_exp_f32 v169, v169
    v_smfmac_f32_32x32x32_bf16 v[96:111], a[52:55], v[160:167], v4
    global_load_dwordx4 a[168:171], v15, s[100:101] sc1
    global_load_dwordx4 a[172:175], v14, s[100:101] sc1
    global_load_dwordx4 a[176:179], v15, s[90:91] sc1
    global_load_dwordx4 a[180:183], v14, s[90:91] sc1
    v_exp_f32 v170, v170
    v_exp_f32 v171, v171
    v_exp_f32 v172, v172
    v_exp_f32 v173, v173
    v_exp_f32 v174, v174
    v_exp_f32 v175, v175
    v_exp_f32 v144, v144
    v_exp_f32 v145, v145
    v_smfmac_f32_32x32x32_bf16 v[96:111], a[56:59], v[168:175], v4
    s_add_u32 s100, s64, s34
    v_exp_f32 v146, v146
    v_exp_f32 v147, v147
    v_exp_f32 v148, v148
    v_mfma_f32_32x32x16_bf16 v[160:175], a[48:51], v[212:215], v[64:79]
    s_addc_u32 s101, s65, 0
    v_exp_f32 v149, v149
    v_exp_f32 v150, v150
    v_exp_f32 v151, v151
    v_exp_f32 v152, v152
    v_exp_f32 v153, v153
    v_smfmac_f32_32x32x32_bf16 v[112:127], a[52:55], v[144:151], v4
    v_exp_f32 v154, v154
    v_exp_f32 v155, v155
    v_exp_f32 v156, v156
    v_exp_f32 v157, v157
    v_exp_f32 v158, v158
    v_exp_f32 v159, v159
    v_exp_f32 v160, v160
    v_exp_f32 v161, v161
    v_smfmac_f32_32x32x32_bf16 v[112:127], a[56:59], v[152:159], v4
    s_waitcnt vmcnt(34)
    v_exp_f32 v162, v162
    v_exp_f32 v163, v163
    v_exp_f32 v164, v164
    v_mfma_f32_32x32x16_bf16 v[144:159], a[60:63], v[200:203], v[16:31]
    s_add_u32 s90, s64, s35
    v_exp_f32 v165, v165
    v_exp_f32 v166, v166
    v_exp_f32 v167, v167
    v_exp_f32 v168, v168
    v_exp_f32_e64 v169, v169
    v_smfmac_f32_32x32x32_bf16 v[128:143], a[52:55], v[160:167], v4
    s_addc_u32 s91, s65, 0
    global_load_dwordx4 a[184:187], v15, s[100:101] sc1
    global_load_dwordx4 a[188:191], v14, s[100:101] sc1
    global_load_dwordx4 a[192:195], v15, s[90:91] sc1
    global_load_dwordx4 a[196:199], v14, s[90:91] sc1
    v_exp_f32 v170, v170
    v_exp_f32 v171, v171
    v_exp_f32 v172, v172
    v_exp_f32 v173, v173
    v_exp_f32 v174, v174
    v_exp_f32 v175, v175
    v_exp_f32 v144, v144
    v_exp_f32 v145, v145
    v_smfmac_f32_32x32x32_bf16 v[128:143], a[56:59], v[168:175], v4
    v_exp_f32 v146, v146
    v_exp_f32 v147, v147
    v_exp_f32 v148, v148
    v_mfma_f32_32x32x16_bf16 v[160:175], a[60:63], v[204:207], v[32:47]
    s_add_u32 s100, s64, s44
    v_exp_f32 v149, v149
    v_exp_f32 v150, v150
    v_exp_f32 v151, v151
    v_exp_f32 v152, v152
    v_exp_f32 v153, v153
    v_smfmac_f32_32x32x32_bf16 v[80:95], a[64:67], v[144:151], v4
    s_addc_u32 s101, s65, 0
    v_exp_f32 v154, v154
    v_exp_f32 v155, v155
    v_exp_f32 v156, v156
    v_exp_f32 v157, v157
    v_exp_f32 v158, v158
    v_exp_f32 v159, v159
    v_exp_f32 v160, v160
    v_exp_f32 v161, v161
    v_smfmac_f32_32x32x32_bf16 v[80:95], a[68:71], v[152:159], v4
    s_add_u32 s90, s64, s45
    v_exp_f32 v162, v162
    v_exp_f32 v163, v163
    v_exp_f32 v164, v164
    v_mfma_f32_32x32x16_bf16 v[144:159], a[60:63], v[208:211], v[48:63]
    s_addc_u32 s91, s65, 0
    v_exp_f32 v165, v165
    v_exp_f32 v166, v166
    v_exp_f32 v167, v167
    v_exp_f32 v168, v168
    v_exp_f32 v169, v169
    v_smfmac_f32_32x32x32_bf16 v[96:111], a[64:67], v[160:167], v4
    global_load_dwordx4 a[200:203], v15, s[100:101] sc1
    global_load_dwordx4 a[204:207], v14, s[100:101] sc1
    global_load_dwordx4 a[208:211], v15, s[90:91] sc1
    global_load_dwordx4 a[212:215], v14, s[90:91] sc1
    v_exp_f32 v170, v170
    v_exp_f32 v171, v171
    v_exp_f32 v172, v172
    v_exp_f32 v173, v173
    v_exp_f32 v174, v174
    v_exp_f32 v175, v175
    v_exp_f32 v144, v144
    v_exp_f32 v145, v145
    v_smfmac_f32_32x32x32_bf16 v[96:111], a[68:71], v[168:175], v4
    v_exp_f32 v146, v146
    v_exp_f32 v147, v147
    v_exp_f32 v148, v148
    v_mfma_f32_32x32x16_bf16 v[160:175], a[60:63], v[212:215], v[64:79]
    v_exp_f32 v149, v149
    v_exp_f32 v150, v150
    v_exp_f32 v151, v151
    v_exp_f32 v152, v152
    v_exp_f32 v153, v153
    v_smfmac_f32_32x32x32_bf16 v[112:127], a[64:67], v[144:151], v4
    v_exp_f32 v154, v154
    v_exp_f32 v155, v155
    v_exp_f32 v156, v156
    v_exp_f32 v157, v157
    v_exp_f32 v158, v158
    v_exp_f32 v159, v159
    v_exp_f32 v160, v160
    v_exp_f32 v161, v161
    v_smfmac_f32_32x32x32_bf16 v[112:127], a[68:71], v[152:159], v4
    s_waitcnt vmcnt(35)
    v_exp_f32 v162, v162
    v_exp_f32 v163, v163
    v_exp_f32 v164, v164
    v_mfma_f32_32x32x16_bf16 v[144:159], a[0:3], v[200:203], v[16:31]
    s_add_u32 s100, s64, s46
    v_exp_f32 v165, v165
    v_exp_f32 v166, v166
    v_exp_f32 v167, v167
    v_exp_f32 v168, v168
    v_exp_f32 v169, v169
    v_smfmac_f32_32x32x32_bf16 v[128:143], a[64:67], v[160:167], v4
    s_addc_u32 s101, s65, 0
    v_exp_f32 v170, v170
    v_exp_f32 v171, v171
    v_exp_f32 v172, v172
    v_exp_f32 v173, v173
    v_exp_f32 v174, v174
    v_exp_f32 v175, v175
    v_exp_f32 v144, v144
    v_exp_f32 v145, v145
    v_smfmac_f32_32x32x32_bf16 v[128:143], a[68:71], v[168:175], v4
    s_add_u32 s90, s64, s47
    v_exp_f32 v146, v146
    v_exp_f32 v147, v147
    v_exp_f32 v148, v148
    v_mfma_f32_32x32x16_bf16 v[160:175], a[0:3], v[204:207], v[32:47]
    s_addc_u32 s91, s65, 0
    v_exp_f32 v149, v149
    v_exp_f32 v150, v150
    v_exp_f32 v151, v151
    v_exp_f32 v152, v152
    v_exp_f32_e64 v153, v153
    v_smfmac_f32_32x32x32_bf16 v[80:95], a[4:7], v[144:151], v4
    global_load_dwordx4 a[216:219], v15, s[100:101] sc1
    global_load_dwordx4 a[220:223], v14, s[100:101] sc1
    global_load_dwordx4 a[224:227], v15, s[90:91] sc1
    global_load_dwordx4 a[228:231], v14, s[90:91] sc1
    v_exp_f32 v154, v154
    v_exp_f32 v155, v155
    v_exp_f32 v156, v156
    v_exp_f32 v157, v157
    v_exp_f32 v158, v158
    v_exp_f32 v159, v159
    v_exp_f32 v160, v160
    v_exp_f32 v161, v161
    v_smfmac_f32_32x32x32_bf16 v[80:95], a[8:11], v[152:159], v4
    v_exp_f32 v162, v162
    v_exp_f32 v163, v163
    v_exp_f32 v164, v164
    v_mfma_f32_32x32x16_bf16 v[144:159], a[0:3], v[208:211], v[48:63]
    s_add_u32 s100, s64, s48
    v_exp_f32 v165, v165
    v_exp_f32 v166, v166
    v_exp_f32 v167, v167
    v_exp_f32 v168, v168
    v_exp_f32 v169, v169
    v_smfmac_f32_32x32x32_bf16 v[96:111], a[4:7], v[160:167], v4
    s_addc_u32 s101, s65, 0
    v_exp_f32 v170, v170
    v_exp_f32 v171, v171
    v_exp_f32 v172, v172
    v_exp_f32 v173, v173
    v_exp_f32 v174, v174
    v_exp_f32 v175, v175
    v_exp_f32 v144, v144
    v_exp_f32 v145, v145
    v_smfmac_f32_32x32x32_bf16 v[96:111], a[8:11], v[168:175], v4
    v_exp_f32 v146, v146
    v_exp_f32 v147, v147
    v_exp_f32 v148, v148
    v_mfma_f32_32x32x16_bf16 v[160:175], a[0:3], v[212:215], v[64:79]
    v_exp_f32 v149, v149
    v_exp_f32 v150, v150
    v_exp_f32 v151, v151
    v_exp_f32 v152, v152
    v_exp_f32 v153, v153
    v_smfmac_f32_32x32x32_bf16 v[112:127], a[4:7], v[144:151], v4
    global_load_dwordx4 a[232:235], v15, s[100:101] sc1
    global_load_dwordx4 a[236:239], v14, s[100:101] sc1
    buffer_load_dwordx4 a[240:243], v15, s[64:67], s49 offen sc1
    buffer_load_dwordx4 a[244:247], v14, s[64:67], s49 offen sc1
    v_exp_f32 v154, v154
    v_exp_f32 v155, v155
    v_exp_f32 v156, v156
    v_exp_f32 v157, v157
    v_exp_f32 v158, v158
    v_exp_f32 v159, v159
    v_exp_f32 v160, v160
    v_exp_f32 v161, v161
    v_smfmac_f32_32x32x32_bf16 v[112:127], a[8:11], v[152:159], v4
    s_waitcnt vmcnt(36)
    v_exp_f32 v162, v162
    v_exp_f32 v163, v163
    v_exp_f32 v164, v164
    v_mfma_f32_32x32x16_bf16 v[144:159], a[12:15], v[200:203], v[16:31]
    v_exp_f32 v165, v165
    v_exp_f32 v166, v166
    v_exp_f32 v167, v167
    v_exp_f32 v168, v168
    v_exp_f32 v169, v169
    v_smfmac_f32_32x32x32_bf16 v[128:143], a[4:7], v[160:167], v4
    v_exp_f32 v170, v170
    v_exp_f32 v171, v171
    v_exp_f32 v172, v172
    v_exp_f32 v173, v173
    v_exp_f32 v174, v174
    v_exp_f32 v175, v175
    v_exp_f32 v144, v144
    v_exp_f32 v145, v145
    v_smfmac_f32_32x32x32_bf16 v[128:143], a[8:11], v[168:175], v4
    v_exp_f32 v146, v146
    v_exp_f32 v147, v147
    v_exp_f32 v148, v148
    v_mfma_f32_32x32x16_bf16 v[160:175], a[12:15], v[204:207], v[32:47]
    v_exp_f32 v149, v149
    v_exp_f32 v150, v150
    v_exp_f32 v151, v151
    v_exp_f32 v152, v152
    v_exp_f32 v153, v153
    v_smfmac_f32_32x32x32_bf16 v[80:95], a[16:19], v[144:151], v4
    v_exp_f32 v154, v154
    v_exp_f32 v155, v155
    v_exp_f32 v156, v156
    v_exp_f32 v157, v157
    v_exp_f32 v158, v158
    v_exp_f32 v159, v159
    v_exp_f32 v160, v160
    v_exp_f32 v161, v161
    v_smfmac_f32_32x32x32_bf16 v[80:95], a[20:23], v[152:159], v4
    v_exp_f32 v162, v162
    v_exp_f32 v163, v163
    v_exp_f32 v164, v164
    v_mfma_f32_32x32x16_bf16 v[144:159], a[12:15], v[208:211], v[48:63]
    v_exp_f32 v165, v165
    v_exp_f32 v166, v166
    v_exp_f32 v167, v167
    v_exp_f32 v168, v168
    v_exp_f32 v169, v169
    v_smfmac_f32_32x32x32_bf16 v[96:111], a[16:19], v[160:167], v4
    v_exp_f32 v170, v170
    v_exp_f32 v171, v171
    v_exp_f32 v172, v172
    v_exp_f32 v173, v173
    v_exp_f32 v174, v174
    v_exp_f32 v175, v175
    v_exp_f32 v144, v144
    v_exp_f32 v145, v145
    v_smfmac_f32_32x32x32_bf16 v[96:111], a[20:23], v[168:175], v4
    ds_write_b128 v251, v[80:83] offset:34816
    ds_write_b32 v251, v88 offset:38912
    v_exp_f32 v146, v146
    v_exp_f32 v147, v147
    v_exp_f32 v148, v148
    v_mfma_f32_32x32x16_bf16 v[160:175], a[12:15], v[212:215], v[64:79]
    ds_write_b128 v251, v[84:87] offset:35840
    v_exp_f32 v149, v149
    v_exp_f32 v150, v150
    v_exp_f32 v151, v151
    v_exp_f32 v152, v152
    v_exp_f32 v153, v153
    v_smfmac_f32_32x32x32_bf16 v[112:127], a[16:19], v[144:151], v4
    v_exp_f32 v154, v154
    v_exp_f32 v155, v155
    v_exp_f32 v156, v156
    v_exp_f32 v157, v157
    v_exp_f32 v158, v158
    v_exp_f32 v159, v159
    v_exp_f32 v160, v160
    v_exp_f32 v161, v161
    v_smfmac_f32_32x32x32_bf16 v[112:127], a[20:23], v[152:159], v4
    ds_write_b128 v251, v[96:99] offset:36864
    ds_write_b32 v251, v104 offset:38916
    ds_write_b128 v251, v[100:103] offset:37888
    v_exp_f32 v162, v162
    v_exp_f32 v163, v163
    v_exp_f32 v164, v164
    v_exp_f32 v165, v165
    v_exp_f32 v166, v166
    v_exp_f32 v167, v167
    v_exp_f32 v168, v168
    v_exp_f32 v169, v169
    v_smfmac_f32_32x32x32_bf16 v[128:143], a[16:19], v[160:167], v4
L_pad8:
    s_cbranch_execz L_warm_back
    v_exp_f32 v170, v170
    v_exp_f32 v171, v171
    v_exp_f32_e64 v172, v172
    s_waitcnt lgkmcnt(0)
    s_barrier
    ds_read_b64 v[88:89], v250 offset:38912
    ds_read_b128 v[80:83], v250 offset:34816
    ds_read_b128 v[84:87], v250 offset:35840
    ds_read_b128 v[96:99], v250 offset:36864
    ds_read_b128 v[100:103], v250 offset:37888
    v_exp_f32 v173, v173
    v_exp_f32 v174, v174
    v_exp_f32_e64 v175, v175
    s_nop 1
    v_smfmac_f32_32x32x32_bf16 v[128:143], a[20:23], v[168:175], v4
    s_waitcnt vmcnt(0)
    ds_read_b64_tr_b16 a[40:41], v9 offset:16384
    ds_read_b64_tr_b16 a[42:43], v9 offset:17408
    ds_read_b64_tr_b16 a[56:57], v10 offset:16384
    ds_read_b64_tr_b16 a[58:59], v10 offset:17408
    ds_read_b64_tr_b16 a[44:45], v9 offset:18432
    ds_read_b64_tr_b16 a[46:47], v9 offset:19456
    ds_read_b64_tr_b16 a[60:61], v10 offset:18432
    ds_read_b64_tr_b16 a[62:63], v10 offset:19456
    s_waitcnt lgkmcnt(12)
    v_add_f32 v120, v120, v88
    v_rcp_f32 v122, v120
    s_waitcnt lgkmcnt(11)
    v_add_f32 v112, v112, v80
    v_add_f32 v113, v113, v81
    v_add_f32 v114, v114, v82
    v_add_f32 v115, v115, v83
    s_waitcnt lgkmcnt(10)
    v_add_f32 v116, v116, v84
    v_add_f32 v117, v117, v85
    v_add_f32 v118, v118, v86
    v_add_f32 v119, v119, v87
    v_max3_f32 v121, |v112|, |v113|, |v114|
    v_max3_f32 v123, |v115|, |v116|, |v117|
    v_max3_f32 v121, |v118|, |v119|, v121
    v_max_f32 v121, v121, v123
    v_mul_f32 v122, v11, v122
    v_mul_f32 v112, v122, v112
    v_mul_f32 v113, v122, v113
    v_mul_f32 v114, v122, v114
    v_mul_f32 v115, v122, v115
    v_mul_f32 v116, v122, v116
    v_mul_f32 v117, v122, v117
    v_mul_f32 v118, v122, v118
    v_mul_f32_e64 v119, v122, v119
    v_cvt_pk_bf16_f32 v124, v112, v113
    v_cvt_pk_bf16_f32 v125, v114, v115
    v_cvt_pk_bf16_f32 v126, v116, v117
    v_cvt_pk_bf16_f32 v127, v118, v119
    v_mul_f32 v252, v112, v113
    v_fmac_f32 v252, v114, v115
    v_fmac_f32 v252, v116, v117
    s_waitcnt lgkmcnt(4)
    v_mfma_f32_32x32x16_bf16 v[16:31], a[40:43], a[72:75], 0
    ds_read_b64_tr_b16 a[48:49], v9 offset:20480
    v_fmac_f32 v252, v118, v119
    v_add_f32 v136, v136, v89
    v_rcp_f32 v138, v136
    v_add_f32 v128, v128, v96
    v_mfma_f32_32x32x16_bf16 v[32:47], a[56:59], a[72:75], 0
    ds_read_b64_tr_b16 a[50:51], v9 offset:21504
    v_add_f32 v129, v129, v97
    v_add_f32 v130, v130, v98
    v_add_f32 v131, v131, v99
    v_add_f32 v132, v132, v100
    v_add_f32 v133, v133, v101
    v_mfma_f32_32x32x16_bf16 v[48:63], a[40:43], a[76:79], 0
    ds_read_b64_tr_b16 a[64:65], v10 offset:20480
    v_add_f32 v134, v134, v102
    v_add_f32_e64 v135, v135, v103
    v_max3_f32 v137, |v128|, |v129|, |v130|
    v_max3_f32 v139, |v131|, |v132|, |v133|
    v_max3_f32 v137, |v134|, |v135|, v137
    v_mfma_f32_32x32x16_bf16 v[64:79], a[56:59], a[76:79], 0
    ds_read_b64_tr_b16 a[66:67], v10 offset:21504
    v_max_f32 v137, v137, v139
    v_mul_f32 v138, v12, v138
    v_mul_f32 v128, v138, v128
    v_mul_f32 v129, v138, v129
    s_waitcnt lgkmcnt(4)
    v_mfma_f32_32x32x16_bf16 v[16:31], a[44:47], a[80:83], v[16:31]
    ds_read_b64_tr_b16 a[52:53], v9 offset:22528
    v_mul_f32 v130, v138, v130
    v_mul_f32 v131, v138, v131
    v_mul_f32 v132, v138, v132
    v_mul_f32 v133, v138, v133
    v_mul_f32 v134, v138, v134
    v_mfma_f32_32x32x16_bf16 v[32:47], a[60:63], a[80:83], v[32:47]
    ds_read_b64_tr_b16 a[54:55], v9 offset:23552
    v_mul_f32_e64 v135, v138, v135
    v_cvt_pk_bf16_f32 v140, v128, v129
    v_cvt_pk_bf16_f32 v141, v130, v131
    v_cvt_pk_bf16_f32 v142, v132, v133
    v_cvt_pk_bf16_f32 v143, v134, v135
    v_mfma_f32_32x32x16_bf16 v[48:63], a[44:47], a[84:87], v[48:63]
    ds_read_b64_tr_b16 a[68:69], v10 offset:22528
    v_fmac_f32 v252, v128, v129
    v_fmac_f32 v252, v130, v131
    v_fmac_f32 v252, v132, v133
    v_fmac_f32 v252, v134, v135
    v_add_u32 v248, s93, v1
    v_mfma_f32_32x32x16_bf16 v[64:79], a[60:63], a[84:87], v[64:79]
    ds_read_b64_tr_b16 a[70:71], v10 offset:23552
    v_mul_f32 v252, 0, v252
    v_min_f32 v253, v121, v137
    v_mul_f32 v253, 0x38800000, v253
    v_min3_f32 v253, v122, v138, v253
    s_waitcnt lgkmcnt(4)
    v_mfma_f32_32x32x16_bf16 v[16:31], a[48:51], a[88:91], v[16:31]
    ds_read_b64_tr_b16 a[40:41], v9 offset:24576
    v_cmp_nlt_f32 vcc, v252, v253
    s_cbranch_vccnz L_fallback
L_ostore:
    global_store_dwordx4 v248, v[124:127], s[60:61] offset:0 sc1
    global_store_dwordx4 v248, v[140:143], s[60:61] offset:1024 sc1
    s_mul_i32 s15, s3, 917504
    s_sub_u32 s15, 4194304, s15
    v_mfma_f32_32x32x16_bf16 v[32:47], a[64:67], a[88:91], v[32:47]
    ds_read_b64_tr_b16 a[42:43], v9 offset:25600
    s_and_b32 s14, s9, 0x3ff
    v_add_u32 v15, s15, v15
    v_add_u32 v14, s15, v14
    v_lshrrev_b32 v13, 5, v0
    v_mfma_f32_32x32x16_bf16 v[48:63], a[48:51], a[92:95], v[48:63]
    ds_read_b64_tr_b16 a[56:57], v10 offset:24576
    v_and_b32 v12, 28, v0
    v_or_b32 v12, v12, v13
    v_lshlrev_b32 v12, 10, v12
    v_and_b32 v3, 3, v0
    v_mfma_f32_32x32x16_bf16 v[64:79], a[64:67], a[92:95], v[64:79]
    ds_read_b64_tr_b16 a[58:59], v10 offset:25600
    v_lshl_add_u32 v12, v3, 4, v12
    v_add_u32 v12, s9, v12
    v_lshlrev_b32 v13, 4, v13
    s_waitcnt lgkmcnt(4)
    v_mfma_f32_32x32x16_bf16 v[16:31], a[52:55], a[96:99], v[16:31]
    ds_read_b64_tr_b16 a[44:45], v9 offset:26624
    v_lshlrev_b32_e64 v3, 2, v0
    s_lshr_b32 s16, s9, 15
    s_lshl_b32 s16, s16, 8
    s_add_u32 s16, s16, 6488064
    v_mfma_f32_32x32x16_bf16 v[32:47], a[68:71], a[96:99], v[32:47]
    ds_read_b64_tr_b16 a[46:47], v9 offset:27648
    s_mov_b32 s84, 0x55555555
    s_mov_b32 s85, 0x55555555
    s_mov_b32 s86, 0x33333333
    s_mov_b32 s87, 0x33333333
    v_mfma_f32_32x32x16_bf16 v[48:63], a[52:55], a[100:103], v[48:63]
    ds_read_b64_tr_b16 a[60:61], v10 offset:26624
    s_xor_b32 s11, s3, 1
    s_mul_i32 s11, s11, 40960
    v_add_u32 v254, s11, v1
    s_xor_b32 s11, s3, 3
    v_mfma_f32_32x32x16_bf16 v[64:79], a[68:71], a[100:103], v[64:79]
    ds_read_b64_tr_b16 a[62:63], v10 offset:27648
    buffer_load_dwordx4 v[200:203], v12, s[40:43], 0 offen offset:0
    s_mul_i32 s11, s11, 40960
    s_waitcnt lgkmcnt(4)
    v_mfma_f32_32x32x16_bf16 v[16:31], a[40:43], a[104:107], v[16:31]
    ds_read_b64_tr_b16 a[48:49], v9 offset:28672
    buffer_load_dwordx4 v[208:211], v13, s[80:83], s14 offen offset:0
    v_add_u32_e64 v255, s11, v1
    v_mfma_f32_32x32x16_bf16 v[32:47], a[56:59], a[104:107], v[32:47]
    ds_read_b64_tr_b16 a[50:51], v9 offset:29696
    buffer_load_dwordx4 v[204:207], v12, s[40:43], 0 offen offset:2048
    v_mfma_f32_32x32x16_bf16 v[48:63], a[40:43], a[108:111], v[48:63]
    ds_read_b64_tr_b16 a[64:65], v10 offset:28672
    buffer_load_dwordx4 v[212:215], v13, s[80:83], s14 offen offset:32
    v_mfma_f32_32x32x16_bf16 v[64:79], a[56:59], a[108:111], v[64:79]
    ds_read_b64_tr_b16 a[66:67], v10 offset:29696
    buffer_load_dword v4, v3, s[60:63], s16 offen sc1
    s_waitcnt lgkmcnt(4)
    v_mfma_f32_32x32x16_bf16 v[16:31], a[44:47], a[112:115], v[16:31]
    s_add_u32 m0, s96, 34816
    ds_read_b64_tr_b16 a[52:53], v9 offset:30720
    buffer_load_dwordx4 v5, s[52:55], s45 offen lds
    v_mfma_f32_32x32x16_bf16 v[32:47], a[60:63], a[112:115], v[32:47]
    ds_read_b64_tr_b16 a[54:55], v9 offset:31744
    v_mfma_f32_32x32x16_bf16 v[48:63], a[44:47], a[116:119], v[48:63]
    ds_read_b64_tr_b16 a[68:69], v10 offset:30720
    buffer_load_dwordx4 v7, s[52:55], s45 offen offset:1024 lds
    v_mfma_f32_32x32x16_bf16 v[64:79], a[60:63], a[116:119], v[64:79]
    s_add_u32 m0, s96, 36864
    ds_read_b64_tr_b16 a[70:71], v10 offset:31744
    s_waitcnt lgkmcnt(4)
    v_mfma_f32_32x32x16_bf16 v[16:31], a[48:51], a[120:123], v[16:31]
    ds_read_b64_tr_b16 a[0:1], v9 offset:32768
    buffer_load_dwordx4 v5, s[52:55], s46 offen lds
    v_mfma_f32_32x32x16_bf16 v[32:47], a[64:67], a[120:123], v[32:47]
    ds_read_b64_tr_b16 a[2:3], v9 offset:33792
    v_mfma_f32_32x32x16_bf16 v[48:63], a[48:51], a[124:127], v[48:63]
    ds_read_b64_tr_b16 a[56:57], v10 offset:32768
    buffer_load_dwordx4 v7, s[52:55], s46 offen offset:1024 lds
    v_mfma_f32_32x32x16_bf16 v[64:79], a[64:67], a[124:127], v[64:79]
    s_add_u32 m0, s96, 38912
    ds_read_b64_tr_b16 a[58:59], v10 offset:33792
    s_waitcnt lgkmcnt(4)
    v_mfma_f32_32x32x16_bf16 v[16:31], a[52:55], a[128:131], v[16:31]
    ds_read_b64_tr_b16 a[4:5], v9 offset:0
    buffer_load_dwordx4 v5, s[52:55], s47 offen lds
    v_mfma_f32_32x32x16_bf16 v[32:47], a[68:71], a[128:131], v[32:47]
    ds_read_b64_tr_b16 a[6:7], v9 offset:1024
    v_mfma_f32_32x32x16_bf16 v[48:63], a[52:55], a[132:135], v[48:63]
    ds_read_b64_tr_b16 a[60:61], v10 offset:0
    buffer_load_dwordx4 v7, s[52:55], s47 offen offset:1024 lds
    v_mfma_f32_32x32x16_bf16 v[64:79], a[68:71], a[132:135], v[64:79]
    s_add_u32 m0, s96, 16384
    ds_read_b64_tr_b16 a[62:63], v10 offset:1024
    s_waitcnt lgkmcnt(4)
    v_mfma_f32_32x32x16_bf16 v[16:31], a[0:3], a[136:139], v[16:31]
    ds_read_b64_tr_b16 a[8:9], v9 offset:2048
    buffer_load_dwordx4 v5, s[52:55], s48 offen lds
    v_mfma_f32_32x32x16_bf16 v[32:47], a[56:59], a[136:139], v[32:47]
    ds_read_b64_tr_b16 a[10:11], v9 offset:3072
    v_mfma_f32_32x32x16_bf16 v[48:63], a[0:3], a[140:143], v[48:63]
    ds_read_b64_tr_b16 a[64:65], v10 offset:2048
    buffer_load_dwordx4 v7, s[52:55], s48 offen offset:1024 lds
    v_mfma_f32_32x32x16_bf16 v[64:79], a[56:59], a[140:143], v[64:79]
    s_add_u32 m0, s96, 18432
    ds_read_b64_tr_b16 a[66:67], v10 offset:3072
    s_waitcnt lgkmcnt(4)
    v_mfma_f32_32x32x16_bf16 v[16:31], a[4:7], a[144:147], v[16:31]
    ds_read_b64_tr_b16 a[12:13], v9 offset:4096
    buffer_load_dwordx4 v5, s[52:55], s49 offen lds
    v_mfma_f32_32x32x16_bf16 v[32:47], a[60:63], a[144:147], v[32:47]
    ds_read_b64_tr_b16 a[14:15], v9 offset:5120
    v_mfma_f32_32x32x16_bf16 v[48:63], a[4:7], a[148:151], v[48:63]
    ds_read_b64_tr_b16 a[68:69], v10 offset:4096
    buffer_load_dwordx4 v7, s[52:55], s49 offen offset:1024 lds
    v_mfma_f32_32x32x16_bf16 v[64:79], a[60:63], a[148:151], v[64:79]
    ds_read_b64_tr_b16 a[70:71], v10 offset:5120
    s_waitcnt lgkmcnt(4)
    v_mfma_f32_32x32x16_bf16 v[16:31], a[8:11], a[152:155], v[16:31]
    ds_read_b64_tr_b16 a[16:17], v9 offset:6144
    v_mfma_f32_32x32x16_bf16 v[32:47], a[64:67], a[152:155], v[32:47]
    ds_read_b64_tr_b16 a[18:19], v9 offset:7168
    v_mfma_f32_32x32x16_bf16 v[48:63], a[8:11], a[156:159], v[48:63]
    ds_read_b64_tr_b16 a[56:57], v10 offset:6144
    s_waitcnt vmcnt(10)
    s_mov_b64 vcc, s[86:87]
    v_cndmask_b32_dpp v160, v204, v200, vcc quad_perm:[2,3,0,1] row_mask:0xf bank_mask:0xf
    v_cndmask_b32_dpp v161, v205, v201, vcc quad_perm:[2,3,0,1] row_mask:0xf bank_mask:0xf
    v_mfma_f32_32x32x16_bf16 v[64:79], a[64:67], a[156:159], v[64:79]
    ds_read_b64_tr_b16 a[58:59], v10 offset:7168
    v_cndmask_b32_dpp v162, v206, v202, vcc quad_perm:[2,3,0,1] row_mask:0xf bank_mask:0xf
    v_cndmask_b32_dpp v163, v207, v203, vcc quad_perm:[2,3,0,1] row_mask:0xf bank_mask:0xf
    s_not_b64 vcc, vcc
    s_waitcnt lgkmcnt(4)
    v_mfma_f32_32x32x16_bf16 v[16:31], a[12:15], a[160:163], v[16:31]
    ds_read_b64_tr_b16 a[20:21], v9 offset:8192
    v_cndmask_b32_dpp v164, v200, v204, vcc quad_perm:[2,3,0,1] row_mask:0xf bank_mask:0xf
    v_cndmask_b32_dpp v165, v201, v205, vcc quad_perm:[2,3,0,1] row_mask:0xf bank_mask:0xf
    v_cndmask_b32_dpp v166, v202, v206, vcc quad_perm:[2,3,0,1] row_mask:0xf bank_mask:0xf
    v_cndmask_b32_dpp v167, v203, v207, vcc quad_perm:[2,3,0,1] row_mask:0xf bank_mask:0xf
    v_mfma_f32_32x32x16_bf16 v[32:47], a[68:71], a[160:163], v[32:47]
    ds_read_b64_tr_b16 a[22:23], v9 offset:9216
    v_permlane32_swap_b32 v160, v162
    v_permlane32_swap_b32 v161, v163
    v_mfma_f32_32x32x16_bf16 v[48:63], a[12:15], a[164:167], v[48:63]
    ds_read_b64_tr_b16 a[60:61], v10 offset:8192
    v_permlane32_swap_b32 v164, v166
    v_permlane32_swap_b32 v165, v167
    v_mfma_f32_32x32x16_bf16 v[64:79], a[68:71], a[164:167], v[64:79]
    ds_read_b64_tr_b16 a[62:63], v10 offset:9216
    s_mov_b64 vcc, s[84:85]
    v_cndmask_b32_dpp v200, v162, v160, vcc quad_perm:[1,0,3,2] row_mask:0xf bank_mask:0xf
    v_cndmask_b32_dpp v201, v163, v161, vcc quad_perm:[1,0,3,2] row_mask:0xf bank_mask:0xf
    s_waitcnt lgkmcnt(4)
    v_mfma_f32_32x32x16_bf16 v[16:31], a[16:19], a[168:171], v[16:31]
    ds_read_b64_tr_b16 a[24:25], v9 offset:10240
    v_cndmask_b32_dpp v204, v166, v164, vcc quad_perm:[1,0,3,2] row_mask:0xf bank_mask:0xf
    v_cndmask_b32_dpp v205, v167, v165, vcc quad_perm:[1,0,3,2] row_mask:0xf bank_mask:0xf
    s_not_b64 vcc, vcc
    v_cndmask_b32_dpp v202, v160, v162, vcc quad_perm:[1,0,3,2] row_mask:0xf bank_mask:0xf
    v_mfma_f32_32x32x16_bf16 v[32:47], a[56:59], a[168:171], v[32:47]
    ds_read_b64_tr_b16 a[26:27], v9 offset:11264
    v_cndmask_b32_dpp v203, v161, v163, vcc quad_perm:[1,0,3,2] row_mask:0xf bank_mask:0xf
    v_cndmask_b32_dpp v206, v164, v166, vcc quad_perm:[1,0,3,2] row_mask:0xf bank_mask:0xf
    v_cndmask_b32_dpp v207, v165, v167, vcc quad_perm:[1,0,3,2] row_mask:0xf bank_mask:0xf
    v_permlane32_swap_b32 v208, v210
    v_mfma_f32_32x32x16_bf16 v[48:63], a[16:19], a[172:175], v[48:63]
    ds_read_b64_tr_b16 a[64:65], v10 offset:10240
    buffer_load_dwordx4 v[84:87], v14, s[60:63], s50 offen sc1
    v_permlane32_swap_b32 v209, v211
    v_mfma_f32_32x32x16_bf16 v[64:79], a[56:59], a[172:175], v[64:79]
    ds_read_b64_tr_b16 a[66:67], v10 offset:11264
    v_permlane32_swap_b32 v212, v214
    v_permlane32_swap_b32 v213, v215
    s_waitcnt lgkmcnt(4)
    v_mfma_f32_32x32x16_bf16 v[16:31], a[20:23], a[176:179], v[16:31]
    ds_read_b64_tr_b16 a[28:29], v9 offset:12288
    buffer_load_dwordx4 v[92:95], v14, s[60:63], s51 offen sc1
    v_lshlrev_b32 v144, 16, v200
    v_and_b32 v145, 0xffff0000, v200
    v_mfma_f32_32x32x16_bf16 v[32:47], a[60:63], a[176:179], v[32:47]
    ds_read_b64_tr_b16 a[30:31], v9 offset:13312
    v_lshlrev_b32 v252, 16, v208
    v_and_b32 v253, 0xffff0000, v208
    v_add_f32 v144, v144, v252
    v_add_f32 v145, v145, v253
    v_mfma_f32_32x32x16_bf16 v[48:63], a[20:23], a[180:183], v[48:63]
    ds_read_b64_tr_b16 a[68:69], v10 offset:12288
    buffer_load_dwordx4 v[100:103], v14, s[60:63], s72 offen sc1
    v_lshlrev_b32 v146, 16, v201
    v_and_b32 v147, 0xffff0000, v201
    v_mfma_f32_32x32x16_bf16 v[64:79], a[60:63], a[180:183], v[64:79]
    ds_read_b64_tr_b16 a[70:71], v10 offset:13312
    v_lshlrev_b32 v252, 16, v209
    v_and_b32 v253, 0xffff0000, v209
    v_add_f32 v146, v146, v252
    s_waitcnt lgkmcnt(4)
    v_mfma_f32_32x32x16_bf16 v[16:31], a[24:27], a[184:187], v[16:31]
    ds_read_b64_tr_b16 a[32:33], v9 offset:14336
    buffer_load_dwordx4 v[108:111], v14, s[60:63], s73 offen sc1
    v_add_f32 v147, v147, v253
    v_lshlrev_b32 v148, 16, v202
    v_mfma_f32_32x32x16_bf16 v[32:47], a[64:67], a[184:187], v[32:47]
    ds_read_b64_tr_b16 a[34:35], v9 offset:15360
    v_and_b32 v149, 0xffff0000, v202
    v_lshlrev_b32 v252, 16, v210
    v_and_b32 v253, 0xffff0000, v210
    v_add_f32 v148, v148, v252
    v_mfma_f32_32x32x16_bf16 v[48:63], a[24:27], a[188:191], v[48:63]
    ds_read_b64_tr_b16 a[56:57], v10 offset:14336
    buffer_load_dwordx4 v[116:119], v14, s[60:63], s74 offen sc1
    v_add_f32_e64 v149, v149, v253
    v_mfma_f32_32x32x16_bf16 v[64:79], a[64:67], a[188:191], v[64:79]
    ds_read_b64_tr_b16 a[58:59], v10 offset:15360
    s_waitcnt vmcnt(5)
    s_waitcnt lgkmcnt(4)
    v_mfma_f32_32x32x16_bf16 v[16:31], a[28:31], a[192:195], v[16:31]
    ds_read_b64_tr_b16 a[36:37], v9 offset:34816
    buffer_load_dwordx4 v[124:127], v14, s[60:63], s75 offen sc1
    v_mfma_f32_32x32x16_bf16 v[32:47], a[68:71], a[192:195], v[32:47]
    ds_read_b64_tr_b16 a[38:39], v9 offset:35840
    v_mfma_f32_32x32x16_bf16 v[48:63], a[28:31], a[196:199], v[48:63]
    ds_read_b64_tr_b16 a[60:61], v10 offset:34816
    buffer_load_dwordx4 v[132:135], v14, s[60:63], s76 offen sc1
    v_mfma_f32_32x32x16_bf16 v[64:79], a[68:71], a[196:199], v[64:79]
    ds_read_b64_tr_b16 a[62:63], v10 offset:35840
    s_waitcnt lgkmcnt(4)
    v_mfma_f32_32x32x16_bf16 v[16:31], a[32:35], a[200:203], v[16:31]
    ds_read_b64_tr_b16 a[40:41], v9 offset:36864
    buffer_load_dwordx4 v[140:143], v14, s[60:63], s77 offen sc1
    v_mfma_f32_32x32x16_bf16 v[32:47], a[56:59], a[200:203], v[32:47]
    ds_read_b64_tr_b16 a[42:43], v9 offset:37888
    v_mfma_f32_32x32x16_bf16 v[48:63], a[32:35], a[204:207], v[48:63]
    ds_read_b64_tr_b16 a[64:65], v10 offset:36864
    buffer_load_dwordx4 v[80:83], v15, s[60:63], s50 offen sc1
    v_mfma_f32_32x32x16_bf16 v[64:79], a[56:59], a[204:207], v[64:79]
    ds_read_b64_tr_b16 a[66:67], v10 offset:37888
    s_waitcnt lgkmcnt(4)
    v_mfma_f32_32x32x16_bf16 v[32:47], a[60:63], a[208:211], v[32:47]
    ds_read_b64_tr_b16 a[44:45], v9 offset:38912
    ds_read_b64_tr_b16 a[46:47], v9 offset:39936
    buffer_load_dwordx4 v[88:91], v15, s[60:63], s51 offen sc1
    v_mfma_f32_32x32x16_bf16 v[48:63], a[36:39], a[212:215], v[48:63]
    ds_read_b64_tr_b16 a[68:69], v10 offset:38912
    v_mfma_f32_32x32x16_bf16 v[64:79], a[60:63], a[212:215], v[64:79]
    ds_read_b64_tr_b16 a[70:71], v10 offset:39936
    buffer_load_dwordx4 v[96:99], v15, s[60:63], s72 offen sc1
    s_waitcnt lgkmcnt(4)
    v_mfma_f32_32x32x16_bf16 v[32:47], a[64:67], a[216:219], v[32:47]
    ds_read_b64_tr_b16 a[48:49], v9 offset:16384
    ds_read_b64_tr_b16 a[50:51], v9 offset:17408
    v_mfma_f32_32x32x16_bf16 v[48:63], a[40:43], a[220:223], v[48:63]
    ds_read_b64_tr_b16 a[56:57], v10 offset:16384
    buffer_load_dwordx4 v[104:107], v15, s[60:63], s73 offen sc1
    v_mfma_f32_32x32x16_bf16 v[64:79], a[64:67], a[220:223], v[64:79]
    ds_read_b64_tr_b16 a[58:59], v10 offset:17408
    s_waitcnt lgkmcnt(4)
    v_mfma_f32_32x32x16_bf16 v[32:47], a[68:71], a[224:227], v[32:47]
    ds_read_b64_tr_b16 a[52:53], v9 offset:18432
    ds_read_b64_tr_b16 a[54:55], v9 offset:19456
    buffer_load_dwordx4 v[112:115], v15, s[60:63], s74 offen sc1
    v_mfma_f32_32x32x16_bf16 v[48:63], a[44:47], a[228:231], v[48:63]
    ds_read_b64_tr_b16 a[60:61], v10 offset:18432
    v_mfma_f32_32x32x16_bf16 v[64:79], a[68:71], a[228:231], v[64:79]
    ds_read_b64_tr_b16 a[62:63], v10 offset:19456
    buffer_load_dwordx4 v[120:123], v15, s[60:63], s75 offen sc1
    s_waitcnt lgkmcnt(4)
    v_mfma_f32_32x32x16_bf16 v[32:47], a[56:59], a[232:235], v[32:47]
    v_mfma_f32_32x32x16_bf16 v[48:63], a[48:51], a[236:239], v[48:63]
    buffer_load_dwordx4 v[128:131], v15, s[60:63], s76 offen sc1
    s_waitcnt vmcnt(7)
    v_max_u32_e64 v11, v84, v85
    v_max3_u32 v11, v86, v87, v11
    v_mfma_f32_32x32x16_bf16 v[64:79], a[56:59], a[236:239], v[64:79]
    v_max3_u32 v11, v92, v93, v11
    v_max3_u32 v11, v94, v95, v11
    v_max3_u32 v11, v100, v101, v11
    v_max3_u32 v11, v102, v103, v11
    s_waitcnt lgkmcnt(0)
    v_mfma_f32_32x32x16_bf16 v[32:47], a[60:63], a[240:243], v[32:47]
    buffer_load_dwordx4 v[136:139], v15, s[60:63], s77 offen sc1
    v_max3_u32 v11, v108, v109, v11
    v_max3_u32 v11, v110, v111, v11
    v_max3_u32 v11, v116, v117, v11
    v_mfma_f32_32x32x16_bf16 v[48:63], a[52:55], a[244:247], v[48:63]
    v_max3_u32 v11, v118, v119, v11
    v_max3_u32 v11, v124, v125, v11
    v_max3_u32 v11, v126, v127, v11
    v_max3_u32 v11, v132, v133, v11
    v_max3_u32 v11, v134, v135, v11
    v_mfma_f32_32x32x16_bf16 v[64:79], a[60:63], a[244:247], v[64:79]
    v_max3_u32 v11, v140, v141, v11
    v_max3_u32 v11, v142, v143, v11
    v_cmp_eq_u32 vcc, -1, v11
    s_cbranch_vccnz L_oretry1
L_ook1:
    v_mfma_f32_32x32x16_bf16 v[64:79], v[180:183], v[84:87], v[64:79]
    v_lshlrev_b32 v150, 16, v203
    v_and_b32 v151, 0xffff0000, v203
    v_lshlrev_b32 v252, 16, v211
    v_and_b32 v253, 0xffff0000, v211
    v_add_f32 v150, v150, v252
    v_add_f32 v151, v151, v253
    v_mfma_f32_32x32x16_bf16 v[64:79], v[188:191], v[92:95], v[64:79]
    v_lshlrev_b32 v152, 16, v204
    v_and_b32 v153, 0xffff0000, v204
    v_lshlrev_b32 v252, 16, v212
    v_and_b32 v253, 0xffff0000, v212
    v_add_f32 v152, v152, v252
    v_add_f32 v153, v153, v253
    v_mfma_f32_32x32x16_bf16 v[64:79], v[196:199], v[100:103], v[64:79]
    v_lshlrev_b32 v154, 16, v205
    v_and_b32 v155, 0xffff0000, v205
    v_lshlrev_b32 v252, 16, v213
    v_and_b32 v253, 0xffff0000, v213
    v_add_f32 v154, v154, v252
    v_add_f32 v155, v155, v253
    v_mfma_f32_32x32x16_bf16 v[64:79], v[220:223], v[108:111], v[64:79]
    v_lshlrev_b32 v156, 16, v206
    v_and_b32 v157, 0xffff0000, v206
    v_lshlrev_b32 v252, 16, v214
    v_and_b32 v253, 0xffff0000, v214
    v_add_f32 v156, v156, v252
    v_add_f32 v157, v157, v253
    v_mfma_f32_32x32x16_bf16 v[64:79], v[228:231], v[116:119], v[64:79]
    v_lshlrev_b32 v158, 16, v207
    v_and_b32 v159, 0xffff0000, v207
    v_lshlrev_b32 v252, 16, v215
    v_and_b32 v253, 0xffff0000, v215
    v_add_f32 v158, v158, v252
    v_add_f32 v159, v159, v253
    v_mfma_f32_32x32x16_bf16 v[64:79], v[236:239], v[124:127], v[64:79]
    v_mfma_f32_32x32x16_bf16 v[64:79], v[244:247], v[132:135], v[64:79]
    v_mfma_f32_32x32x16_bf16 v[64:79], a[252:255], v[140:143], v[64:79]
    s_waitcnt vmcnt(0)
    v_max_u32_e64 v11, v80, v81
    v_max3_u32 v11, v82, v83, v11
    v_max3_u32 v11, v88, v89, v11
    v_max3_u32 v11, v90, v91, v11
    v_max3_u32 v11, v96, v97, v11
    v_mfma_f32_32x32x16_bf16 v[48:63], v[176:179], v[84:87], v[48:63]
    v_max3_u32 v11, v98, v99, v11
    v_max3_u32 v11, v104, v105, v11
    v_max3_u32 v11, v106, v107, v11
    v_max3_u32 v11, v112, v113, v11
    v_max3_u32 v11, v114, v115, v11
    v_max3_u32 v11, v120, v121, v11
    v_mfma_f32_32x32x16_bf16 v[48:63], v[184:187], v[92:95], v[48:63]
    v_max3_u32 v11, v122, v123, v11
    v_max3_u32 v11, v128, v129, v11
    v_max3_u32 v11, v130, v131, v11
    v_max3_u32 v11, v136, v137, v11
    v_max3_u32 v11, v138, v139, v11
    v_cmp_eq_u32 vcc, -1, v11
    v_mfma_f32_32x32x16_bf16 v[48:63], v[192:195], v[100:103], v[48:63]
    ds_write_b128 v250, v[64:67] offset:28672
    v_mfma_f32_32x32x16_bf16 v[48:63], v[216:219], v[108:111], v[48:63]
    v_mfma_f32_32x32x16_bf16 v[48:63], v[224:227], v[116:119], v[48:63]
    ds_write_b128 v250, v[68:71] offset:29696
    v_mfma_f32_32x32x16_bf16 v[48:63], v[232:235], v[124:127], v[48:63]
    v_mfma_f32_32x32x16_bf16 v[48:63], v[240:243], v[132:135], v[48:63]
    ds_write_b128 v250, v[72:75] offset:30720
    v_mfma_f32_32x32x16_bf16 v[48:63], a[248:251], v[140:143], v[48:63]
    s_cbranch_vccnz L_oretry0
L_ook0:
    v_mfma_f32_32x32x16_bf16 v[32:47], v[180:183], v[80:83], v[32:47]
    ds_write_b128 v250, v[76:79] offset:31744
    v_mfma_f32_32x32x16_bf16 v[32:47], v[188:191], v[88:91], v[32:47]
    s_nop 4
    v_mfma_f32_32x32x16_bf16 v[32:47], v[196:199], v[96:99], v[32:47]
    s_nop 1
    ds_write_b128 v250, v[48:51] offset:24576
    v_mfma_f32_32x32x16_bf16 v[32:47], v[220:223], v[104:107], v[32:47]
    s_waitcnt lgkmcnt(1)
    s_barrier
    ds_read_b128 v[64:67], v255 offset:28672
    ds_read_b128 v[68:71], v255 offset:29696
    ds_read_b128 v[72:75], v255 offset:30720
    ds_read_b128 v[76:79], v255 offset:31744
    v_mfma_f32_32x32x16_bf16 v[32:47], v[228:231], v[112:115], v[32:47]
    ds_write_b128 v250, v[52:55] offset:25600
    v_mfma_f32_32x32x16_bf16 v[32:47], v[236:239], v[120:123], v[32:47]
    v_mfma_f32_32x32x16_bf16 v[32:47], v[244:247], v[128:131], v[32:47]
    ds_write_b128 v250, v[56:59] offset:26624
    v_mfma_f32_32x32x16_bf16 v[32:47], a[252:255], v[136:139], v[32:47]
    s_waitcnt lgkmcnt(2)
    v_fmac_f32 v144, v4, v64
    v_fmac_f32 v145, v4, v65
    v_fmac_f32 v146, v4, v66
    v_fmac_f32 v147, v4, v67
    v_fmac_f32 v148, v4, v68
    v_mfma_f32_32x32x16_bf16 v[16:31], v[176:179], v[80:83], v[16:31]
    ds_write_b128 v250, v[60:63] offset:27648
    v_mfma_f32_32x32x16_bf16 v[16:31], v[184:187], v[88:91], v[16:31]
    v_fmac_f32 v149, v4, v69
    v_fmac_f32 v150, v4, v70
    v_fmac_f32 v151, v4, v71
    v_fmac_f32 v152, v4, v72
    v_fmac_f32 v153, v4, v73
    v_fmac_f32 v154, v4, v74
    v_mfma_f32_32x32x16_bf16 v[16:31], v[192:195], v[96:99], v[16:31]
    ds_write_b128 v250, v[32:35] offset:20480
    v_mfma_f32_32x32x16_bf16 v[16:31], v[216:219], v[104:107], v[16:31]
    s_waitcnt lgkmcnt(1)
    s_barrier
    ds_read_b128 v[48:51], v251 offset:24576
    ds_read_b128 v[52:55], v251 offset:25600
    ds_read_b128 v[56:59], v251 offset:26624
    ds_read_b128 v[60:63], v251 offset:27648
    v_fmac_f32 v155, v4, v75
    v_mfma_f32_32x32x16_bf16 v[16:31], v[224:227], v[112:115], v[16:31]
    ds_write_b128 v250, v[36:39] offset:21504
    v_mfma_f32_32x32x16_bf16 v[16:31], v[232:235], v[120:123], v[16:31]
    v_fmac_f32 v156, v4, v76
    v_fmac_f32 v157, v4, v77
    v_fmac_f32 v158, v4, v78
    v_fmac_f32 v159, v4, v79
    v_mfma_f32_32x32x16_bf16 v[16:31], v[240:243], v[128:131], v[16:31]
    ds_write_b128 v250, v[40:43] offset:22528
    v_mfma_f32_32x32x16_bf16 v[16:31], a[248:251], v[136:139], v[16:31]
    s_waitcnt lgkmcnt(2)
    v_fmac_f32 v144, v4, v48
    v_fmac_f32 v145, v4, v49
    v_fmac_f32 v146, v4, v50
    v_fmac_f32 v147, v4, v51
    v_fmac_f32 v148, v4, v52
    v_mfma_f32_32x32x16_bf16 v[16:31], a[36:39], a[208:211], v[16:31]
    ds_write_b128 v250, v[44:47] offset:23552
    v_mfma_f32_32x32x16_bf16 v[16:31], a[40:43], a[216:219], v[16:31]
    v_fmac_f32 v149, v4, v53
    v_fmac_f32 v150, v4, v54
    v_fmac_f32 v151, v4, v55
    v_fmac_f32 v152, v4, v56
    v_fmac_f32 v153, v4, v57
    v_fmac_f32 v154, v4, v58
    v_mfma_f32_32x32x16_bf16 v[16:31], a[44:47], a[224:227], v[16:31]
    s_waitcnt lgkmcnt(0)
    s_barrier
    ds_read_b128 v[32:35], v254 offset:20480
    ds_read_b128 v[36:39], v254 offset:21504
    ds_read_b128 v[40:43], v254 offset:22528
    ds_read_b128 v[44:47], v254 offset:23552
    v_fmac_f32 v155, v4, v59
    v_mfma_f32_32x32x16_bf16 v[16:31], a[48:51], a[232:235], v[16:31]
    v_fmac_f32 v156, v4, v60
    v_fmac_f32 v157, v4, v61
    v_fmac_f32 v158, v4, v62
    v_fmac_f32 v159, v4, v63
    v_mfma_f32_32x32x16_bf16 v[16:31], a[52:55], a[240:243], v[16:31]
    s_waitcnt lgkmcnt(3)
    s_nop 10
    v_pk_add_f32 v[16:17], v[16:17], v[32:33]
    v_pk_add_f32 v[18:19], v[18:19], v[34:35]
    s_waitcnt lgkmcnt(2)
    v_pk_add_f32 v[20:21], v[20:21], v[36:37]
    v_pk_add_f32 v[22:23], v[22:23], v[38:39]
    s_waitcnt lgkmcnt(1)
    v_pk_add_f32 v[24:25], v[24:25], v[40:41]
    v_pk_add_f32 v[26:27], v[26:27], v[42:43]
    s_waitcnt lgkmcnt(0)
    s_nop 0
    v_pk_add_f32 v[28:29], v[28:29], v[44:45]
    v_pk_add_f32 v[30:31], v[30:31], v[46:47]
    v_pk_fma_f32 v[16:17], v[16:17], v[4:5], v[144:145] op_sel_hi:[1,0,1]
    v_pk_fma_f32 v[18:19], v[18:19], v[4:5], v[146:147] op_sel_hi:[1,0,1]
    v_pk_fma_f32 v[20:21], v[20:21], v[4:5], v[148:149] op_sel_hi:[1,0,1]
    v_pk_fma_f32 v[22:23], v[22:23], v[4:5], v[150:151] op_sel_hi:[1,0,1]
    v_pk_fma_f32 v[24:25], v[24:25], v[4:5], v[152:153] op_sel_hi:[1,0,1]
    v_pk_fma_f32 v[26:27], v[26:27], v[4:5], v[154:155] op_sel_hi:[1,0,1]
    v_pk_fma_f32 v[28:29], v[28:29], v[4:5], v[156:157] op_sel_hi:[1,0,1]
    v_pk_fma_f32 v[30:31], v[30:31], v[4:5], v[158:159] op_sel_hi:[1,0,1]
    v_cvt_pk_bf16_f32 v80, v16, v17
    v_cvt_pk_bf16_f32 v81, v18, v19
    v_cvt_pk_bf16_f32 v82, v20, v21
    v_cvt_pk_bf16_f32 v83, v22, v23
    v_cvt_pk_bf16_f32 v84, v24, v25
    v_cvt_pk_bf16_f32 v85, v26, v27
    v_cvt_pk_bf16_f32 v86, v28, v29
    v_cvt_pk_bf16_f32 v87, v30, v31
    s_mov_b64 vcc, s[84:85]
    v_cndmask_b32_dpp v88, v82, v80, vcc quad_perm:[1,0,3,2] row_mask:0xf bank_mask:0xf
    v_cndmask_b32_dpp v89, v83, v81, vcc quad_perm:[1,0,3,2] row_mask:0xf bank_mask:0xf
    v_cndmask_b32_dpp v92, v86, v84, vcc quad_perm:[1,0,3,2] row_mask:0xf bank_mask:0xf
    v_cndmask_b32_dpp v93, v87, v85, vcc quad_perm:[1,0,3,2] row_mask:0xf bank_mask:0xf
    s_not_b64 vcc, vcc
    v_cndmask_b32_dpp v90, v80, v82, vcc quad_perm:[1,0,3,2] row_mask:0xf bank_mask:0xf
    v_cndmask_b32_dpp v91, v81, v83, vcc quad_perm:[1,0,3,2] row_mask:0xf bank_mask:0xf
    v_cndmask_b32_dpp v94, v84, v86, vcc quad_perm:[1,0,3,2] row_mask:0xf bank_mask:0xf
    v_cndmask_b32_dpp v95, v85, v87, vcc quad_perm:[1,0,3,2] row_mask:0xf bank_mask:0xf
    v_permlane32_swap_b32 v88, v90
    v_permlane32_swap_b32 v89, v91
    v_permlane32_swap_b32 v92, v94
    v_permlane32_swap_b32 v93, v95
L_pad9:
    s_cbranch_execz L_warm_back
    s_mov_b64 vcc, s[86:87]
    v_cndmask_b32_dpp v80, v92, v88, vcc quad_perm:[2,3,0,1] row_mask:0xf bank_mask:0xf
    v_cndmask_b32_dpp v81, v93, v89, vcc quad_perm:[2,3,0,1] row_mask:0xf bank_mask:0xf
    v_cndmask_b32_dpp v82, v94, v90, vcc quad_perm:[2,3,0,1] row_mask:0xf bank_mask:0xf
    v_cndmask_b32_dpp v83, v95, v91, vcc quad_perm:[2,3,0,1] row_mask:0xf bank_mask:0xf
    global_store_dwordx4 v12, v[80:83], s[68:69] sc1
    s_not_b64 vcc, vcc
    v_cndmask_b32_dpp v84, v88, v92, vcc quad_perm:[2,3,0,1] row_mask:0xf bank_mask:0xf
    v_cndmask_b32_dpp v85, v89, v93, vcc quad_perm:[2,3,0,1] row_mask:0xf bank_mask:0xf
    v_cndmask_b32_dpp v86, v90, v94, vcc quad_perm:[2,3,0,1] row_mask:0xf bank_mask:0xf
    v_cndmask_b32_dpp v87, v91, v95, vcc quad_perm:[2,3,0,1] row_mask:0xf bank_mask:0xf
    global_store_dwordx4 v12, v[84:87], s[68:69] offset:2048 sc1
L_end:
    s_endpgm
L_oretry1:
L_pad10:
    s_cbranch_execz L_warm_back
    s_mov_b32 s12, 400000
    v_and_b32 v13, 7, v0
    v_lshlrev_b32 v13, 16, v13
    v_readfirstlane_b32 s13, v14
    s_nop 4
L_opoll1:
    s_sub_u32 s12, s12, 1
    s_cmp_eq_u32 s12, 0
    s_cbranch_scc1 L_ook1
    buffer_load_dword v8, v13, s[60:63], s13 offen offset:1020 sc1
    s_waitcnt vmcnt(0)
    v_cmp_eq_u32 vcc, -1, v8
    s_cbranch_vccz L_oload1
    s_sleep 4
    s_branch L_opoll1
L_oload1:
    s_nop 0
    buffer_load_dwordx4 v[84:87], v14, s[60:63], s50 offen sc1
    buffer_load_dwordx4 v[92:95], v14, s[60:63], s51 offen sc1
    buffer_load_dwordx4 v[100:103], v14, s[60:63], s72 offen sc1
    buffer_load_dwordx4 v[108:111], v14, s[60:63], s73 offen sc1
    buffer_load_dwordx4 v[116:119], v14, s[60:63], s74 offen sc1
    buffer_load_dwordx4 v[124:127], v14, s[60:63], s75 offen sc1
    buffer_load_dwordx4 v[132:135], v14, s[60:63], s76 offen sc1
    buffer_load_dwordx4 v[140:143], v14, s[60:63], s77 offen sc1
    buffer_load_dwordx4 v[80:83], v15, s[60:63], s50 offen sc1
    buffer_load_dwordx4 v[88:91], v15, s[60:63], s51 offen sc1
    buffer_load_dwordx4 v[96:99], v15, s[60:63], s72 offen sc1
    buffer_load_dwordx4 v[104:107], v15, s[60:63], s73 offen sc1
    buffer_load_dwordx4 v[112:115], v15, s[60:63], s74 offen sc1
    buffer_load_dwordx4 v[120:123], v15, s[60:63], s75 offen sc1
    buffer_load_dwordx4 v[128:131], v15, s[60:63], s76 offen sc1
    buffer_load_dwordx4 v[136:139], v15, s[60:63], s77 offen sc1
    s_waitcnt vmcnt(8)
    v_max_u32 v11, v84, v85
    v_max3_u32 v11, v86, v87, v11
    v_max3_u32 v11, v92, v93, v11
    v_max3_u32 v11, v94, v95, v11
    v_max3_u32 v11, v100, v101, v11
    v_max3_u32 v11, v102, v103, v11
    v_max3_u32 v11, v108, v109, v11
    v_max3_u32 v11, v110, v111, v11
    v_max3_u32 v11, v116, v117, v11
    v_max3_u32 v11, v118, v119, v11
    v_max3_u32 v11, v124, v125, v11
    v_max3_u32 v11, v126, v127, v11
    v_max3_u32 v11, v132, v133, v11
    v_max3_u32 v11, v134, v135, v11
    v_max3_u32 v11, v140, v141, v11
    v_max3_u32 v11, v142, v143, v11
    v_cmp_eq_u32 vcc, -1, v11
    s_cbranch_vccnz L_opoll1
    s_branch L_ook1
L_oretry0:
L_pad11:
    s_cbranch_execz L_warm_back
    s_mov_b32 s12, 400000
    v_and_b32 v13, 7, v0
    v_lshlrev_b32 v13, 16, v13
    v_readfirstlane_b32 s13, v15
    s_nop 4
L_opoll0:
    s_sub_u32 s12, s12, 1
    s_cmp_eq_u32 s12, 0
    s_cbranch_scc1 L_ook0
    buffer_load_dword v8, v13, s[60:63], s13 offen offset:1020 sc1
    s_waitcnt vmcnt(0)
    v_cmp_eq_u32 vcc, -1, v8
    s_cbranch_vccz L_oload0
    s_sleep 4
    s_branch L_opoll0
L_oload0:
    buffer_load_dwordx4 v[80:83], v15, s[60:63], s50 offen sc1
    buffer_load_dwordx4 v[88:91], v15, s[60:63], s51 offen sc1
    buffer_load_dwordx4 v[96:99], v15, s[60:63], s72 offen sc1
    buffer_load_dwordx4 v[104:107], v15, s[60:63], s73 offen sc1
    buffer_load_dwordx4 v[112:115], v15, s[60:63], s74 offen sc1
    buffer_load_dwordx4 v[120:123], v15, s[60:63], s75 offen sc1
    buffer_load_dwordx4 v[128:131], v15, s[60:63], s76 offen sc1
    buffer_load_dwordx4 v[136:139], v15, s[60:63], s77 offen sc1
    s_waitcnt vmcnt(0)
    v_max_u32 v11, v80, v81
    v_max3_u32 v11, v82, v83, v11
    v_max3_u32 v11, v88, v89, v11
    v_max3_u32 v11, v90, v91, v11
    v_max3_u32 v11, v96, v97, v11
    v_max3_u32 v11, v98, v99, v11
    v_max3_u32 v11, v104, v105, v11
    v_max3_u32 v11, v106, v107, v11
    v_max3_u32 v11, v112, v113, v11
    v_max3_u32 v11, v114, v115, v11
    v_max3_u32 v11, v120, v121, v11
    v_max3_u32 v11, v122, v123, v11
    v_max3_u32 v11, v128, v129, v11
    v_max3_u32 v11, v130, v131, v11
    v_max3_u32 v11, v136, v137, v11
    v_max3_u32 v11, v138, v139, v11
    v_cmp_eq_u32 vcc, -1, v11
    s_cbranch_vccnz L_opoll0
    s_branch L_ook0
L_go_retry:
    s_mov_b32 s97, 400000
L_go_loop:
    s_sleep 4
    buffer_load_dword v7, v8, s[72:75], s70 offen sc1
    s_waitcnt vmcnt(0)
    v_cmp_ne_u32 vcc, s71, v7
    s_sub_u32 s97, s97, 1
    s_cbranch_vccz L_go_ok
    s_cmp_lg_u32 s97, 0
    s_cbranch_scc1 L_go_loop
    s_branch L_go_ok
L_kv_retry:
    s_mov_b32 s97, 400000
L_kv_loop:
    s_sleep 4
    buffer_load_dword v8, v6, s[60:63], s13 offen sc1
    s_waitcnt vmcnt(0)
    v_cmp_ne_u32 vcc, 1, v8
    s_sub_u32 s97, s97, 1
    s_cbranch_vccz L_kv_ok
    s_cmp_lg_u32 s97, 0
    s_cbranch_scc1 L_kv_loop
    s_branch L_kv_ok
L_h_retry:
    s_mov_b32 s97, 400000
L_h_loop:
    s_sleep 4
    buffer_load_dword v8, v6, s[60:63], s92 offen sc1
    s_waitcnt vmcnt(0)
    v_cmp_ne_u32 vcc, 1, v8
    s_sub_u32 s97, s97, 1
    s_cbranch_vccz L_h_ok
    s_cmp_lg_u32 s97, 0
    s_cbranch_scc1 L_h_loop
    s_branch L_h_ok
L_fallback:
    s_lshl_b32 s10, s4, 1
    s_and_b32 s11, s3, 1
    s_add_u32 s10, s10, s11
    s_lshl_b32 s12, s10, 17
    s_mov_b32 s94, s12
    s_mov_b32 s97, 64
    v_mov_b32 v252, 0xff800000
    v_mov_b32 v253, 0xff800000
L_fb1:
    buffer_load_dwordx4 a[0:3], v1, s[60:63], s94 offen sc1
    s_waitcnt vmcnt(0)
    v_mfma_f32_32x32x16_bf16 v[144:159], a[0:3], v[208:211], 0
    v_mfma_f32_32x32x16_bf16 v[160:175], a[0:3], v[212:215], 0
    s_nop 15
    v_max3_f32 v252, v144, v145, v252
    v_max3_f32 v252, v146, v147, v252
    v_max3_f32 v252, v148, v149, v252
    v_max3_f32 v252, v150, v151, v252
    v_max3_f32 v252, v152, v153, v252
    v_max3_f32 v252, v154, v155, v252
    v_max3_f32 v252, v156, v157, v252
    v_max3_f32 v252, v158, v159, v252
    v_max3_f32 v253, v160, v161, v253
    v_max3_f32 v253, v162, v163, v253
    v_max3_f32 v253, v164, v165, v253
    v_max3_f32 v253, v166, v167, v253
    v_max3_f32 v253, v168, v169, v253
    v_max3_f32 v253, v170, v171, v253
    v_max3_f32 v253, v172, v173, v253
    v_max3_f32 v253, v174, v175, v253
    s_add_u32 s94, s94, 2048
    s_sub_u32 s97, s97, 1
    s_cmp_lg_u32 s97, 0
    s_cbranch_scc1 L_fb1
    v_mov_b32 v8, v252
    s_nop 1
    v_permlane32_swap_b32 v252, v8
    v_max_f32 v252, v252, v8
    v_sub_f32 v80, 0, v252
    v_sub_f32 v81, 0, v252
    v_sub_f32 v82, 0, v252
    v_sub_f32 v83, 0, v252
    v_sub_f32 v84, 0, v252
    v_sub_f32 v85, 0, v252
    v_sub_f32 v86, 0, v252
    v_sub_f32 v87, 0, v252
    v_sub_f32 v88, 0, v252
    v_sub_f32 v89, 0, v252
    v_sub_f32 v90, 0, v252
    v_sub_f32 v91, 0, v252
    v_sub_f32 v92, 0, v252
    v_sub_f32 v93, 0, v252
    v_sub_f32 v94, 0, v252
    v_sub_f32 v95, 0, v252
    v_mov_b32 v112, 0
    v_mov_b32 v113, 0
    v_mov_b32 v114, 0
    v_mov_b32 v115, 0
    v_mov_b32 v116, 0
    v_mov_b32 v117, 0
    v_mov_b32 v118, 0
    v_mov_b32 v119, 0
    v_mov_b32 v120, 0
    v_mov_b32 v121, 0
    v_mov_b32 v122, 0
    v_mov_b32 v123, 0
    v_mov_b32 v124, 0
    v_mov_b32 v125, 0
    v_mov_b32 v126, 0
    v_mov_b32 v127, 0
    v_mov_b32 v8, v253
    s_nop 1
    v_permlane32_swap_b32 v253, v8
    v_max_f32 v253, v253, v8
    v_sub_f32 v96, 0, v253
    v_sub_f32 v97, 0, v253
    v_sub_f32 v98, 0, v253
    v_sub_f32 v99, 0, v253
    v_sub_f32 v100, 0, v253
    v_sub_f32 v101, 0, v253
    v_sub_f32 v102, 0, v253
    v_sub_f32 v103, 0, v253
    v_sub_f32 v104, 0, v253
    v_sub_f32 v105, 0, v253
    v_sub_f32 v106, 0, v253
    v_sub_f32 v107, 0, v253
    v_sub_f32 v108, 0, v253
    v_sub_f32 v109, 0, v253
    v_sub_f32 v110, 0, v253
    v_sub_f32 v111, 0, v253
    v_mov_b32 v128, 0
    v_mov_b32 v129, 0
    v_mov_b32 v130, 0
    v_mov_b32 v131, 0
    v_mov_b32 v132, 0
    v_mov_b32 v133, 0
    v_mov_b32 v134, 0
    v_mov_b32 v135, 0
    v_mov_b32 v136, 0
    v_mov_b32 v137, 0
    v_mov_b32 v138, 0
    v_mov_b32 v139, 0
    v_mov_b32 v140, 0
    v_mov_b32 v141, 0
    v_mov_b32 v142, 0
    v_mov_b32 v143, 0
    s_mov_b32 s94, s12
    s_mov_b32 s97, 64
    v_lshrrev_b32 v13, 5, v0
    v_lshlrev_b32 v13, 8, v13
    v_and_b32 v8, 15, v0
    v_lshl_add_u32 v13, v8, 4, v13
L_fb2:
    buffer_load_dwordx4 a[0:3], v1, s[60:63], s94 offen sc1
    s_mov_b64 exec, s[88:89]
    buffer_load_dwordx4 a[4:7], v13, s[60:63], s94 offen offset:1024 sc1
    buffer_load_dwordx4 a[8:11], v13, s[60:63], s94 offen offset:1536 sc1
    s_mov_b64 exec, -1
    s_waitcnt vmcnt(0)
    v_mfma_f32_32x32x16_bf16 v[144:159], a[0:3], v[208:211], v[80:95]
    v_mfma_f32_32x32x16_bf16 v[160:175], a[0:3], v[212:215], v[96:111]
    s_nop 15
    v_exp_f32 v144, v144
    v_exp_f32 v145, v145
    v_exp_f32 v146, v146
    v_exp_f32 v147, v147
    v_exp_f32 v148, v148
    v_exp_f32 v149, v149
    v_exp_f32 v150, v150
    v_exp_f32 v151, v151
    v_exp_f32 v152, v152
    v_exp_f32 v153, v153
    v_exp_f32 v154, v154
    v_exp_f32 v155, v155
    v_exp_f32 v156, v156
    v_exp_f32 v157, v157
    v_exp_f32 v158, v158
    v_exp_f32 v159, v159
    v_exp_f32 v160, v160
    v_exp_f32 v161, v161
    v_exp_f32 v162, v162
    v_exp_f32 v163, v163
    v_exp_f32 v164, v164
    v_exp_f32 v165, v165
    v_exp_f32 v166, v166
    v_exp_f32 v167, v167
    v_exp_f32 v168, v168
    v_exp_f32 v169, v169
    v_exp_f32 v170, v170
    v_exp_f32 v171, v171
    v_exp_f32 v172, v172
    v_exp_f32 v173, v173
    v_exp_f32 v174, v174
    v_exp_f32 v175, v175
    s_nop 1
    v_smfmac_f32_32x32x32_bf16 v[112:127], a[4:7], v[144:151], v4
    v_smfmac_f32_32x32x32_bf16 v[112:127], a[8:11], v[152:159], v4
    v_smfmac_f32_32x32x32_bf16 v[128:143], a[4:7], v[160:167], v4
    v_smfmac_f32_32x32x32_bf16 v[128:143], a[8:11], v[168:175], v4
    s_nop 15
    s_add_u32 s94, s94, 2048
    s_sub_u32 s97, s97, 1
    s_cmp_lg_u32 s97, 0
    s_cbranch_scc1 L_fb2
    s_nop 15
    v_rcp_f32 v122, v120
    v_max3_f32 v121, |v112|, |v113|, |v114|
    v_max3_f32 v123, |v115|, |v116|, |v117|
    v_max3_f32 v121, |v118|, |v119|, v121
    v_max_f32 v121, v121, v123
    v_mul_f32 v122, v11, v122
    v_mul_f32 v112, v122, v112
    v_mul_f32 v113, v122, v113
    v_mul_f32 v114, v122, v114
    v_mul_f32 v115, v122, v115
    v_mul_f32 v116, v122, v116
    v_mul_f32 v117, v122, v117
    v_mul_f32 v118, v122, v118
    v_mul_f32 v119, v122, v119
    v_cvt_pk_bf16_f32 v124, v112, v113
    v_cvt_pk_bf16_f32 v125, v114, v115
    v_cvt_pk_bf16_f32 v126, v116, v117
    v_cvt_pk_bf16_f32 v127, v118, v119
    v_mul_f32 v252, v112, v113
    v_fmac_f32 v252, v114, v115
    v_fmac_f32 v252, v116, v117
    v_fmac_f32 v252, v118, v119
    v_rcp_f32 v138, v136
    v_max3_f32 v137, |v128|, |v129|, |v130|
    v_max3_f32 v139, |v131|, |v132|, |v133|
    v_max3_f32 v137, |v134|, |v135|, v137
    v_max_f32 v137, v137, v139
    v_mul_f32 v138, v12, v138
    v_mul_f32 v128, v138, v128
    v_mul_f32 v129, v138, v129
    v_mul_f32 v130, v138, v130
    v_mul_f32 v131, v138, v131
    v_mul_f32 v132, v138, v132
    v_mul_f32 v133, v138, v133
    v_mul_f32 v134, v138, v134
    v_mul_f32 v135, v138, v135
    v_cvt_pk_bf16_f32 v140, v128, v129
    v_cvt_pk_bf16_f32 v141, v130, v131
    v_cvt_pk_bf16_f32 v142, v132, v133
    v_cvt_pk_bf16_f32 v143, v134, v135
    v_fmac_f32 v252, v128, v129
    v_fmac_f32 v252, v130, v131
    v_fmac_f32 v252, v132, v133
    v_fmac_f32 v252, v134, v135
    s_nop 1
    s_branch L_ostore
    s_endpgm
.p2align 10
L_codeend:
    s_endpgm
.section .rodata,"a"
.p2align 6
.amdhsa_kernel parallel_sum__softmax_full_mha__dense_activation_squared_relu__prompt_kernel
  .amdhsa_next_free_vgpr 512
  .amdhsa_next_free_sgpr 102
  .amdhsa_accum_offset 256
  .amdhsa_group_segment_fixed_size 0
  .amdhsa_kernarg_size 88
  .amdhsa_user_sgpr_count 2
  .amdhsa_user_sgpr_kernarg_segment_ptr 1
  .amdhsa_system_sgpr_workgroup_id_x 1
.end_amdhsa_kernel
```
